```python
import torch

def _softmax(x, axis=-1):
    return torch.softmax(x, dim=axis)

def _gelu(x):
    return torch.nn.functional.gelu(x, approximate='tanh')

def _silu(x):
    return torch.nn.functional.silu(x)

def _sigmoid(x):
    return torch.sigmoid(x)

def _layernorm(x, axis=-1, eps=1e-05):
    m = x.mean(dim=axis, keepdim=True)
    v = x.var(dim=axis, keepdim=True, unbiased=False)
    return (x - m) / torch.sqrt(v + eps)

def _scatter_add(tgt, idx, src, axis=0):
    return tgt.clone().index_add_(axis, idx, src)

def _segment_sum(src, seg, n):
    out = torch.zeros((n,) + src.shape[1:], dtype=src.dtype)
    return out.index_add_(0, seg, src)

def _pad(x, pw):
    flat = tuple((v for pair in reversed(pw) for v in pair))
    return torch.nn.functional.pad(x, flat)
kernel_name = 'adaLN_cond__mha_block_cached__dense_activation_silu__decode'

def setup_inputs():

    _w = lambda a: (lambda t: t.to(torch.bfloat16) if t.is_floating_point() else t)(torch.as_tensor(a))

    def _A_setup():
        B, Sq, D = (4, 1, 512)
        H, Sk, Dh = (32, 4096, 128)
        return {'x': _w((lambda *s: torch.randn(*s, dtype=torch.bfloat16) * 0.1)(B, Sq, D)), 'k_cache': _w((lambda *s: torch.randn(*s, dtype=torch.bfloat16) * 0.8)(B, H, Sk, Dh)), 'v_cache': _w((lambda *s: torch.randn(*s, dtype=torch.bfloat16) * 3.2)(B, H, Sk, Dh)), 'wq': _w((lambda *s: torch.randn(*s, dtype=torch.bfloat16) * 0.8)(D, H * Dh) * D ** (-0.5)), 'wo': _w((lambda *s: torch.randn(*s, dtype=torch.bfloat16) * 3.2)(H * Dh, D) * (H * Dh) ** (-0.5))}
    _A_in = _A_setup()

    def _B_setup():
        B, S, D, F = (4, 1, 512, 1792)
        return {'x': _w((lambda *s: torch.randn(*s, dtype=torch.bfloat16) * 0.1)(B, S, D)), 'w1': _w((lambda *s: torch.randn(*s, dtype=torch.bfloat16) * 3.2)(D, F) * D ** (-0.5)), 'w2': _w((lambda *s: torch.randn(*s, dtype=torch.bfloat16) * 3.2)(F, D) * F ** (-0.5))}
    _B_in = _B_setup()
    return {'A_x': _A_in['x'], 'A_k_cache': _A_in['k_cache'], 'A_v_cache': _A_in['v_cache'], 'A_wq': _A_in['wq'], 'A_wo': _A_in['wo'], 'B_x': _B_in['x'], 'B_w1': _B_in['w1'], 'B_w2': _B_in['w2'], 'c': _w((lambda *s: torch.randn(*s, dtype=torch.bfloat16) * 0.1)(4, 512) * 8.0), 'w_mod': _w((lambda *s: torch.randn(*s, dtype=torch.bfloat16) * 0.1)(512, 6 * 512) * 512 ** (-0.5) * 8.0)}

def reference(A_x, A_k_cache, A_v_cache, A_wq, A_wo, B_x, B_w1, B_w2, c, w_mod):

    def _A_ref(x, k_cache, v_cache, wq, wo):
        B, Sq, D = x.shape
        H, Dh = (32, 128)
        q = (lambda x, *d: x.permute(*d))((x @ wq).reshape(B, Sq, H, Dh), 0, 2, 1, 3)
        scores = torch.einsum('bhqd,bhkd->bhqk', q, k_cache) * Dh ** (-0.5)
        p = _softmax(scores, axis=-1)
        o = torch.einsum('bhqk,bhkd->bhqd', p, v_cache)
        return (lambda x, *d: x.permute(*d))(o, 0, 2, 1, 3).reshape(B, Sq, H * Dh) @ wo

    def _B_ref(x, w1, w2):
        h = torch.einsum('bsd,df->bsf', x, w1)
        h = _silu(h)
        out = torch.einsum('bsf,fd->bsd', h, w2)
        return out
    x = A_x
    mod = (_silu(c) @ w_mod).reshape(c.shape[0], 6, 1, -1)
    sa, ca, ga, sb, cb, gb = (mod[:, 0].clone(), mod[:, 1].clone(), mod[:, 2].clone(), mod[:, 3].clone(), mod[:, 4].clone(), mod[:, 5].clone())
    h = _layernorm(x, axis=-1) * (1 + ca) + sa
    x = x + ga * _A_ref(h, A_k_cache, A_v_cache, A_wq, A_wo)
    h = _layernorm(x, axis=-1) * (1 + cb) + sb
    x = x + gb * _B_ref(h, B_w1, B_w2)
    return x
```

```asm
; @launch grid=(256,1,1) block=(512,1,1) lds=163840
.amdgcn_target "amdgcn-amd-amdhsa--gfx950"
.text
.globl adaLN_cond__mha_block_cached__dense_activation_silu__decode_kernel
.p2align 8
.type adaLN_cond__mha_block_cached__dense_activation_silu__decode_kernel,@function
adaLN_cond__mha_block_cached__dense_activation_silu__decode_kernel:
  s_load_dwordx16 s[4:19], s[0:1], 0
  s_load_dwordx8 s[20:27], s[0:1], 64
  s_load_dwordx2 s[28:29], s[0:1], 96
  v_lshrrev_b32 v4, 6, v0
  v_and_b32 v1, 63, v0
  v_readfirstlane_b32 s3, v4
  v_lshlrev_b32 v7, 4, v1
  s_cmpk_ge_u32 s2, 0x100
  s_cbranch_scc1 L_end
  s_lshr_b32 s30, s2, 6
  s_and_b32 s31, s2, 31
  s_lshr_b32 s33, s2, 5
  s_and_b32 s32, s33, 1
  s_cmp_lt_u32 s2, 32
  s_cselect_b32 s88, 4, s3
  s_cmp_ge_u32 s88, 4
  s_cbranch_scc1 L_H0
L_S:
  s_lshl_b32 s88, s30, 5
  s_add_u32 s88, s88, s31
  s_lshl_b32 s88, s88, 4
  s_add_u32 s88, s88, s32
  s_lshl_b32 s88, s88, 4
  s_add_u32 s88, s88, s3
  s_lshl_b32 s88, s88, 12
  v_add_u32 v4, s88, v7
  s_add_u32 s91, s3, 1
  s_lshl_b32 s91, s91, 15
  s_brev_b32 s38, 16
  s_mov_b32 s39, 0x20000
  s_waitcnt lgkmcnt(0)
  s_mov_b64 s[36:37], s[6:7]
  s_add_u32 m0, s91, 0
  s_mov_b32 s88, 0
  buffer_load_dwordx4 v4, s[36:39], s88 offen offset:0 nt lds
  buffer_load_dwordx4 v4, s[36:39], s88 offen offset:1024 nt lds
  buffer_load_dwordx4 v4, s[36:39], s88 offen offset:2048 nt lds
  buffer_load_dwordx4 v4, s[36:39], s88 offen offset:3072 nt lds
  s_add_u32 m0, s91, 4096
  s_mov_b32 s88, 16384
  buffer_load_dwordx4 v4, s[36:39], s88 offen offset:0 nt lds
  s_mov_b32 s40, s8
  s_mov_b32 s41, s9
  s_mov_b32 s42, 134217728
  s_mov_b32 s43, 0x20000
  v_lshl_add_u32 v7, v1, 4, s91
  v_and_b32 v2, 15, v0
  v_lshrrev_b32 v3, 4, v1
  s_cmp_lt_u32 s2, 32
  s_cbranch_scc1 L_noB0
  s_barrier
L_noB0:
  s_mov_b32 s48, 0x11111111
  s_mov_b32 s49, 0x11111111
  s_mov_b32 s50, 0x22222222
  s_mov_b32 s51, 0x22222222
  s_mov_b32 s52, 0x44444444
  s_mov_b32 s53, 0x44444444
  s_mov_b32 s54, 0x88888888
  s_mov_b32 s55, 0x88888888
  v_and_b32 v5, 1, v2
  v_mov_b32 v6, 0xffff
  v_lshlrev_b32 v5, 4, v5
  v_lshlrev_b32 v6, v5, v6
  v_lshrrev_b32 v5, 1, v2
  v_cmp_eq_u32 vcc, 0, v5
  s_nop 1
  v_cndmask_b32 v36, 0, v6, vcc
  v_cmp_eq_u32 vcc, 1, v5
  s_nop 1
  v_cndmask_b32 v37, 0, v6, vcc
  v_cmp_eq_u32 vcc, 2, v5
  s_nop 1
  v_cndmask_b32 v38, 0, v6, vcc
  v_cmp_eq_u32 vcc, 3, v5
  s_nop 1
  v_cndmask_b32 v39, 0, v6, vcc
  v_lshlrev_b32 v5, 4, v2
  v_mov_b32 v40, 0
  s_cmp_lt_u32 s2, 32
  s_cselect_b64 vcc, -1, 0
  s_cbranch_vccnz L_w_1
  s_waitcnt vmcnt(4)
L_w_1:
  s_waitcnt vmcnt(7)
  buffer_load_dwordx4 v4, s[36:39], s88 offen offset:1024 nt lds
  s_cbranch_vccnz L_w_2
  s_waitcnt vmcnt(4)
L_w_2:
  s_waitcnt vmcnt(7)
  buffer_load_dwordx4 v4, s[36:39], s88 offen offset:2048 nt lds
  s_cbranch_vccnz L_w_3
  s_waitcnt vmcnt(4)
L_w_3:
  s_waitcnt vmcnt(7)
  buffer_load_dwordx4 v4, s[36:39], s88 offen offset:3072 nt lds
  s_cbranch_vccnz L_w_4
  s_waitcnt vmcnt(4)
L_w_4:
  s_waitcnt vmcnt(7)
  s_add_u32 m0, s91, 8192
  s_mov_b32 s88, 32768
  buffer_load_dwordx4 v4, s[36:39], s88 offen offset:0 nt lds
  s_cbranch_vccnz L_w_5
  s_waitcnt vmcnt(4)
L_w_5:
  s_waitcnt vmcnt(7)
  buffer_load_dwordx4 v4, s[36:39], s88 offen offset:1024 nt lds
  s_cbranch_vccnz L_w_6
  s_waitcnt vmcnt(4)
L_w_6:
  s_waitcnt vmcnt(7)
  buffer_load_dwordx4 v4, s[36:39], s88 offen offset:2048 nt lds
  s_cbranch_vccnz L_w_7
  s_waitcnt vmcnt(4)
L_w_7:
  s_waitcnt vmcnt(7)
  buffer_load_dwordx4 v4, s[36:39], s88 offen offset:3072 nt lds
  s_cbranch_vccnz L_w_8
  s_waitcnt vmcnt(4)
L_w_8:
  s_waitcnt vmcnt(7)
  s_add_u32 m0, s91, 12288
  s_mov_b32 s88, 49152
  buffer_load_dwordx4 v4, s[36:39], s88 offen offset:0 nt lds
  s_cbranch_vccnz L_w_9
  s_waitcnt vmcnt(4)
L_w_9:
  s_waitcnt vmcnt(7)
  buffer_load_dwordx4 v4, s[36:39], s88 offen offset:1024 nt lds
  s_cbranch_vccnz L_w_10
  s_waitcnt vmcnt(4)
L_w_10:
  s_waitcnt vmcnt(7)
  buffer_load_dwordx4 v4, s[36:39], s88 offen offset:2048 nt lds
  s_cbranch_vccnz L_w_11
  s_waitcnt vmcnt(4)
L_w_11:
  s_waitcnt vmcnt(7)
  buffer_load_dwordx4 v4, s[36:39], s88 offen offset:3072 nt lds
  s_cbranch_vccnz L_w_12
  s_waitcnt vmcnt(4)
L_w_12:
  s_waitcnt vmcnt(7)
  s_add_u32 m0, s91, 16384
  s_mov_b32 s88, 131072
  buffer_load_dwordx4 v4, s[36:39], s88 offen offset:0 nt lds
  s_cbranch_vccnz L_w_13
  s_waitcnt vmcnt(4)
L_w_13:
  s_waitcnt vmcnt(7)
  buffer_load_dwordx4 v4, s[36:39], s88 offen offset:1024 nt lds
  s_cbranch_vccnz L_w_14
  s_waitcnt vmcnt(4)
L_w_14:
  s_waitcnt vmcnt(7)
  buffer_load_dwordx4 v4, s[36:39], s88 offen offset:2048 nt lds
  s_cbranch_vccnz L_w_15
  s_waitcnt vmcnt(4)
L_w_15:
  s_waitcnt vmcnt(7)
  buffer_load_dwordx4 v4, s[36:39], s88 offen offset:3072 nt lds
  s_cbranch_vccnz L_w_16
  s_waitcnt vmcnt(4)
L_w_16:
  s_waitcnt vmcnt(7)
  s_add_u32 m0, s91, 20480
  s_mov_b32 s88, 147456
  buffer_load_dwordx4 v4, s[36:39], s88 offen offset:0 nt lds
  s_cbranch_vccnz L_w_17
  s_waitcnt vmcnt(4)
L_w_17:
  s_waitcnt vmcnt(7)
  buffer_load_dwordx4 v4, s[36:39], s88 offen offset:1024 nt lds
  s_cbranch_vccnz L_w_18
  s_waitcnt vmcnt(4)
L_w_18:
  s_waitcnt vmcnt(7)
  buffer_load_dwordx4 v4, s[36:39], s88 offen offset:2048 nt lds
  s_cbranch_vccnz L_w_19
  s_waitcnt vmcnt(4)
L_w_19:
  s_waitcnt vmcnt(7)
  buffer_load_dwordx4 v4, s[36:39], s88 offen offset:3072 nt lds
  s_cbranch_vccnz L_w_20
  s_waitcnt vmcnt(4)
L_w_20:
  s_waitcnt vmcnt(7)
  s_add_u32 m0, s91, 24576
  s_mov_b32 s88, 163840
  buffer_load_dwordx4 v4, s[36:39], s88 offen offset:0 nt lds
  v_mov_b32 v41, 24
  ds_write_b32 v40, v41 offset:12
  s_cbranch_vccnz L_w_21
  s_waitcnt vmcnt(4)
L_w_21:
  s_waitcnt vmcnt(7)
  buffer_load_dwordx4 v4, s[36:39], s88 offen offset:1024 nt lds
  s_cbranch_vccnz L_w_22
  s_waitcnt vmcnt(4)
L_w_22:
  s_waitcnt vmcnt(7)
  buffer_load_dwordx4 v4, s[36:39], s88 offen offset:2048 nt lds
  s_cbranch_vccnz L_w_23
  s_waitcnt vmcnt(4)
L_w_23:
  s_waitcnt vmcnt(7)
  buffer_load_dwordx4 v4, s[36:39], s88 offen offset:3072 nt lds
  s_cbranch_vccnz L_w_24
  s_waitcnt vmcnt(4)
L_w_24:
  s_waitcnt vmcnt(7)
  s_add_u32 m0, s91, 28672
  s_mov_b32 s88, 180224
  buffer_load_dwordx4 v4, s[36:39], s88 offen offset:0 nt lds
  s_cbranch_vccnz L_w_25
  s_waitcnt vmcnt(4)
L_w_25:
  s_waitcnt vmcnt(7)
  buffer_load_dwordx4 v4, s[36:39], s88 offen offset:1024 nt lds
  s_cbranch_vccnz L_w_26
  s_waitcnt vmcnt(4)
L_w_26:
  s_waitcnt vmcnt(7)
  buffer_load_dwordx4 v4, s[36:39], s88 offen offset:2048 nt lds
  s_cbranch_vccnz L_w_27
  s_waitcnt vmcnt(4)
L_w_27:
  s_waitcnt vmcnt(7)
  buffer_load_dwordx4 v4, s[36:39], s88 offen offset:3072 nt lds
  s_cbranch_vccnz L_w_28
  s_waitcnt vmcnt(4)
L_w_28:
  s_waitcnt vmcnt(7)
  s_mov_b32 s88, 262144
  buffer_load_dwordx4 v[48:51], v4, s[36:39], s88 offen offset:0 nt
  s_cbranch_vccnz L_w_29
  s_waitcnt vmcnt(4)
L_w_29:
  s_waitcnt vmcnt(7)
  buffer_load_dwordx4 v[52:55], v4, s[36:39], s88 offen offset:1024 nt
  s_cbranch_vccnz L_w_30
  s_waitcnt vmcnt(4)
L_w_30:
  s_waitcnt vmcnt(7)
  buffer_load_dwordx4 v[56:59], v4, s[36:39], s88 offen offset:2048 nt
  s_cbranch_vccnz L_w_31
  s_waitcnt vmcnt(4)
L_w_31:
  s_waitcnt vmcnt(7)
  buffer_load_dwordx4 v[60:63], v4, s[36:39], s88 offen offset:3072 nt
  s_cbranch_vccnz L_w_32
  s_waitcnt vmcnt(4)
L_w_32:
  s_waitcnt vmcnt(7)
  s_mov_b32 s88, 278528
  buffer_load_dwordx4 v[64:67], v4, s[36:39], s88 offen offset:0 nt
  s_cbranch_vccnz L_w_33
  s_waitcnt vmcnt(4)
L_w_33:
  s_waitcnt vmcnt(7)
  buffer_load_dwordx4 v[68:71], v4, s[36:39], s88 offen offset:1024 nt
  s_cbranch_vccnz L_w_34
  s_waitcnt vmcnt(4)
L_w_34:
  s_waitcnt vmcnt(7)
  buffer_load_dwordx4 v[72:75], v4, s[36:39], s88 offen offset:2048 nt
  s_cbranch_vccnz L_w_35
  s_waitcnt vmcnt(4)
L_w_35:
  s_waitcnt vmcnt(7)
  buffer_load_dwordx4 v[76:79], v4, s[36:39], s88 offen offset:3072 nt
  s_cbranch_vccnz L_w_36
  s_waitcnt vmcnt(4)
L_w_36:
  s_waitcnt vmcnt(7)
  s_mov_b32 s88, 294912
  buffer_load_dwordx4 v[80:83], v4, s[36:39], s88 offen offset:0 nt
  v_mov_b32 v41, 40
  ds_write_b32 v40, v41 offset:12
  s_cbranch_vccnz L_w_37
  s_waitcnt vmcnt(4)
L_w_37:
  s_waitcnt vmcnt(7)
  buffer_load_dwordx4 v[84:87], v4, s[36:39], s88 offen offset:1024 nt
  s_cbranch_vccnz L_w_38
  s_waitcnt vmcnt(4)
L_w_38:
  s_waitcnt vmcnt(7)
  buffer_load_dwordx4 v[88:91], v4, s[36:39], s88 offen offset:2048 nt
  s_cbranch_vccnz L_w_39
  s_waitcnt vmcnt(4)
L_w_39:
  s_waitcnt vmcnt(7)
  buffer_load_dwordx4 v[92:95], v4, s[36:39], s88 offen offset:3072 nt
  s_cbranch_vccnz L_w_40
  s_waitcnt vmcnt(4)
L_w_40:
  s_waitcnt vmcnt(7)
  s_mov_b32 s88, 311296
  buffer_load_dwordx4 v[96:99], v4, s[36:39], s88 offen offset:0 nt
  s_cbranch_vccnz L_w_41
  s_waitcnt vmcnt(4)
L_w_41:
  s_waitcnt vmcnt(7)
  buffer_load_dwordx4 v[100:103], v4, s[36:39], s88 offen offset:1024 nt
  s_cbranch_vccnz L_w_42
  s_waitcnt vmcnt(4)
L_w_42:
  s_waitcnt vmcnt(7)
  buffer_load_dwordx4 v[104:107], v4, s[36:39], s88 offen offset:2048 nt
  s_cbranch_vccnz L_w_43
  s_waitcnt vmcnt(4)
L_w_43:
  s_waitcnt vmcnt(7)
  buffer_load_dwordx4 v[108:111], v4, s[36:39], s88 offen offset:3072 nt
  s_cbranch_vccnz L_w_44
  s_waitcnt vmcnt(4)
L_w_44:
  s_waitcnt vmcnt(7)
  s_mov_b32 s88, 393216
  buffer_load_dwordx4 v[112:115], v4, s[36:39], s88 offen offset:0 nt
  s_cbranch_vccnz L_w_45
  s_waitcnt vmcnt(4)
L_w_45:
  s_waitcnt vmcnt(7)
  buffer_load_dwordx4 v[116:119], v4, s[36:39], s88 offen offset:1024 nt
  s_cbranch_vccnz L_w_46
  s_waitcnt vmcnt(4)
L_w_46:
  s_waitcnt vmcnt(7)
  buffer_load_dwordx4 v[120:123], v4, s[36:39], s88 offen offset:2048 nt
  s_cbranch_vccnz L_w_47
  s_waitcnt vmcnt(4)
L_w_47:
  s_waitcnt vmcnt(7)
  buffer_load_dwordx4 v[124:127], v4, s[36:39], s88 offen offset:3072 nt
  s_cbranch_vccnz L_w_48
  s_waitcnt vmcnt(4)
L_w_48:
  s_waitcnt vmcnt(7)
  s_mov_b32 s88, 409600
  buffer_load_dwordx4 v[128:131], v4, s[36:39], s88 offen offset:0 nt
  s_cbranch_vccnz L_w_49
  s_waitcnt vmcnt(4)
L_w_49:
  s_waitcnt vmcnt(7)
  buffer_load_dwordx4 v[132:135], v4, s[36:39], s88 offen offset:1024 nt
  s_cbranch_vccnz L_w_50
  s_waitcnt vmcnt(4)
L_w_50:
  s_waitcnt vmcnt(7)
  buffer_load_dwordx4 v[136:139], v4, s[36:39], s88 offen offset:2048 nt
  s_cbranch_vccnz L_w_51
  s_waitcnt vmcnt(4)
L_w_51:
  s_waitcnt vmcnt(7)
  buffer_load_dwordx4 v[140:143], v4, s[36:39], s88 offen offset:3072 nt
  s_cbranch_vccnz L_w_52
  s_waitcnt vmcnt(4)
L_w_52:
  s_waitcnt vmcnt(7)
  s_mov_b32 s88, 425984
  buffer_load_dwordx4 v[144:147], v4, s[36:39], s88 offen offset:0 nt
  s_cbranch_vccnz L_w_53
  s_waitcnt vmcnt(4)
L_w_53:
  s_waitcnt vmcnt(7)
  buffer_load_dwordx4 v[148:151], v4, s[36:39], s88 offen offset:1024 nt
  s_cbranch_vccnz L_w_54
  s_waitcnt vmcnt(4)
L_w_54:
  s_waitcnt vmcnt(7)
  buffer_load_dwordx4 v[152:155], v4, s[36:39], s88 offen offset:2048 nt
  s_cbranch_vccnz L_w_55
  s_waitcnt vmcnt(4)
L_w_55:
  s_waitcnt vmcnt(7)
  buffer_load_dwordx4 v[156:159], v4, s[36:39], s88 offen offset:3072 nt
  s_cbranch_vccnz L_w_56
  s_waitcnt vmcnt(4)
L_w_56:
  s_waitcnt vmcnt(7)
  s_mov_b32 s88, 442368
  buffer_load_dwordx4 v[160:163], v4, s[36:39], s88 offen offset:0 nt
  s_cbranch_vccnz L_w_57
  s_waitcnt vmcnt(4)
L_w_57:
  s_waitcnt vmcnt(7)
  buffer_load_dwordx4 v[164:167], v4, s[36:39], s88 offen offset:1024 nt
  s_cbranch_vccnz L_w_58
  s_waitcnt vmcnt(4)
L_w_58:
  s_waitcnt vmcnt(7)
  buffer_load_dwordx4 v[168:171], v4, s[36:39], s88 offen offset:2048 nt
  s_cbranch_vccnz L_w_59
  s_waitcnt vmcnt(4)
L_w_59:
  s_waitcnt vmcnt(7)
  buffer_load_dwordx4 v[172:175], v4, s[36:39], s88 offen offset:3072 nt
  s_cbranch_vccnz L_w_60
  s_waitcnt vmcnt(4)
L_w_60:
  s_waitcnt vmcnt(7)
  s_mov_b32 s88, 524288
  buffer_load_dwordx4 v[176:179], v4, s[36:39], s88 offen offset:0 nt
  s_cbranch_vccnz L_w_61
  s_waitcnt vmcnt(4)
L_w_61:
  s_waitcnt vmcnt(7)
  buffer_load_dwordx4 v[180:183], v4, s[36:39], s88 offen offset:1024 nt
  s_cbranch_vccnz L_w_62
  s_waitcnt vmcnt(4)
L_w_62:
  s_waitcnt vmcnt(7)
  buffer_load_dwordx4 v[184:187], v4, s[36:39], s88 offen offset:2048 nt
  s_cbranch_vccnz L_w_63
  s_waitcnt vmcnt(4)
L_w_63:
  s_waitcnt vmcnt(7)
  buffer_load_dwordx4 v[188:191], v4, s[36:39], s88 offen offset:3072 nt
  s_cbranch_vccnz L_w_64
  s_waitcnt vmcnt(4)
L_w_64:
  s_waitcnt vmcnt(7)
  s_mov_b32 s88, 540672
  buffer_load_dwordx4 v[192:195], v4, s[36:39], s88 offen offset:0 nt
  s_cbranch_vccnz L_w_65
  s_waitcnt vmcnt(4)
L_w_65:
  s_waitcnt vmcnt(7)
  buffer_load_dwordx4 v[196:199], v4, s[36:39], s88 offen offset:1024 nt
  s_cbranch_vccnz L_w_66
  s_waitcnt vmcnt(4)
L_w_66:
  s_waitcnt vmcnt(7)
  buffer_load_dwordx4 v[200:203], v4, s[36:39], s88 offen offset:2048 nt
  v_mov_b32 v41, 70
  ds_write_b32 v40, v41 offset:12
  s_cbranch_vccnz L_w_67
  s_waitcnt vmcnt(4)
L_w_67:
  s_waitcnt vmcnt(7)
  buffer_load_dwordx4 v[204:207], v4, s[36:39], s88 offen offset:3072 nt
  s_cbranch_vccnz L_w_68
  s_waitcnt vmcnt(4)
L_w_68:
  s_waitcnt vmcnt(7)
  s_mov_b32 s88, 557056
  buffer_load_dwordx4 v[208:211], v4, s[36:39], s88 offen offset:0 nt
  s_cbranch_vccnz L_w_69
  s_waitcnt vmcnt(4)
L_w_69:
  s_waitcnt vmcnt(7)
  buffer_load_dwordx4 v[212:215], v4, s[36:39], s88 offen offset:1024 nt
  s_cbranch_vccnz L_w_70
  s_waitcnt vmcnt(4)
L_w_70:
  s_waitcnt vmcnt(7)
  buffer_load_dwordx4 v[216:219], v4, s[36:39], s88 offen offset:2048 nt
  s_cbranch_vccnz L_w_71
  s_waitcnt vmcnt(4)
L_w_71:
  s_waitcnt vmcnt(7)
  buffer_load_dwordx4 v[220:223], v4, s[36:39], s88 offen offset:3072 nt
  s_cbranch_vccnz L_w_72
  s_waitcnt vmcnt(4)
L_w_72:
  s_waitcnt vmcnt(7)
  s_mov_b32 s88, 573440
  buffer_load_dwordx4 v[224:227], v4, s[36:39], s88 offen offset:0 nt
  s_cbranch_vccnz L_w_73
  s_waitcnt vmcnt(4)
L_w_73:
  s_waitcnt vmcnt(7)
  buffer_load_dwordx4 v[228:231], v4, s[36:39], s88 offen offset:1024 nt
  s_cbranch_vccnz L_w_74
  s_waitcnt vmcnt(4)
L_w_74:
  s_waitcnt vmcnt(7)
  buffer_load_dwordx4 v[232:235], v4, s[36:39], s88 offen offset:2048 nt
  s_cbranch_vccnz L_w_75
  s_waitcnt vmcnt(4)
L_w_75:
  s_waitcnt vmcnt(7)
  buffer_load_dwordx4 v[236:239], v4, s[36:39], s88 offen offset:3072 nt
  s_cbranch_vccnz L_w_76
  s_waitcnt vmcnt(4)
L_w_76:
  s_waitcnt vmcnt(7)
  s_mov_b32 s88, 655360
  buffer_load_dwordx4 v[240:243], v4, s[36:39], s88 offen offset:0 nt
  s_cbranch_vccnz L_w_77
  s_waitcnt vmcnt(4)
L_w_77:
  s_waitcnt vmcnt(7)
  buffer_load_dwordx4 v[244:247], v4, s[36:39], s88 offen offset:1024 nt
  s_cbranch_vccnz L_w_78
  s_waitcnt vmcnt(4)
L_w_78:
  s_waitcnt vmcnt(7)
  buffer_load_dwordx4 v[248:251], v4, s[36:39], s88 offen offset:2048 nt
  s_cbranch_vccnz L_w_79
  s_waitcnt vmcnt(4)
L_w_79:
  s_waitcnt vmcnt(7)
  buffer_load_dwordx4 v[252:255], v4, s[36:39], s88 offen offset:3072 nt
  s_barrier
  ds_read_b128 v[8:11], v5 offset:256
  s_waitcnt lgkmcnt(0)
  s_mul_i32 s89, s3, 320
  v_lshrrev_b32 v5, 2, v2
  v_lshlrev_b32 v5, 6, v5
  v_and_b32 v6, 3, v2
  v_lshl_add_u32 v5, v6, 2, v5
  v_lshl_add_u32 v5, v3, 1, v5
  s_bfe_u32 s90, s31, 131072
  s_lshl_b32 s90, s90, 6
  v_xor_b32 v5, s90, v5
  v_add_u32 v5, s89, v5
  v_dot2_f32_bf16 v20, v48, v8, 0
  v_dot2_f32_bf16 v21, v52, v8, 0
  v_dot2_f32_bf16 v22, v56, v8, 0
  v_dot2_f32_bf16 v23, v60, v8, 0
  v_dot2c_f32_bf16 v20, v49, v9
  v_dot2c_f32_bf16 v21, v53, v9
  v_dot2c_f32_bf16 v22, v57, v9
  v_dot2c_f32_bf16 v23, v61, v9
  v_dot2c_f32_bf16 v20, v50, v10
  v_dot2c_f32_bf16 v21, v54, v10
  v_dot2c_f32_bf16 v22, v58, v10
  v_dot2c_f32_bf16 v23, v62, v10
  v_dot2c_f32_bf16 v20, v51, v11
  v_dot2c_f32_bf16 v21, v55, v11
  v_dot2c_f32_bf16 v22, v59, v11
  v_dot2c_f32_bf16 v23, v63, v11
  v_add_f32_dpp v24, v20, v20 row_ror:8 row_mask:0xf bank_mask:0x3
  s_nop 1
  v_add_f32_dpp v24, v21, v21 row_ror:8 row_mask:0xf bank_mask:0xc
  v_add_f32_dpp v25, v22, v22 row_ror:8 row_mask:0xf bank_mask:0x3
  s_nop 1
  v_add_f32_dpp v25, v23, v23 row_ror:8 row_mask:0xf bank_mask:0xc
  v_add_f32_dpp v26, v24, v24 row_half_mirror row_mask:0xf bank_mask:0x5
  s_nop 1
  v_add_f32_dpp v26, v25, v25 row_half_mirror row_mask:0xf bank_mask:0xa
  s_nop 1
  v_add_f32_dpp v26, v26, v26 quad_perm:[1,0,3,2] row_mask:0xf bank_mask:0xf
  s_nop 1
  v_add_f32_dpp v14, v26, v26 quad_perm:[2,3,0,1] row_mask:0xf bank_mask:0xf
  s_cmp_lt_u32 s2, 0
  s_cselect_b64 vcc, -1, 0
  s_waitcnt vmcnt(4)
  s_mov_b32 s88, 671744
  buffer_load_dwordx4 v[48:51], v4, s[36:39], s88 offen offset:0 nt
  s_waitcnt vmcnt(4)
  buffer_load_dwordx4 v[52:55], v4, s[36:39], s88 offen offset:1024 nt
  s_waitcnt vmcnt(4)
  buffer_load_dwordx4 v[56:59], v4, s[36:39], s88 offen offset:2048 nt
  s_waitcnt vmcnt(4)
  buffer_load_dwordx4 v[60:63], v4, s[36:39], s88 offen offset:3072 nt
  v_dot2_f32_bf16 v20, v64, v8, 0
  v_dot2_f32_bf16 v21, v68, v8, 0
  v_dot2_f32_bf16 v22, v72, v8, 0
  v_dot2_f32_bf16 v23, v76, v8, 0
  v_dot2c_f32_bf16 v20, v65, v9
  v_dot2c_f32_bf16 v21, v69, v9
  v_dot2c_f32_bf16 v22, v73, v9
  v_dot2c_f32_bf16 v23, v77, v9
  v_dot2c_f32_bf16 v20, v66, v10
  v_dot2c_f32_bf16 v21, v70, v10
  v_dot2c_f32_bf16 v22, v74, v10
  v_dot2c_f32_bf16 v23, v78, v10
  v_dot2c_f32_bf16 v20, v67, v11
  v_dot2c_f32_bf16 v21, v71, v11
  v_dot2c_f32_bf16 v22, v75, v11
  v_dot2c_f32_bf16 v23, v79, v11
  v_add_f32_dpp v24, v20, v20 row_ror:8 row_mask:0xf bank_mask:0x3
  s_nop 1
  v_add_f32_dpp v24, v21, v21 row_ror:8 row_mask:0xf bank_mask:0xc
  v_add_f32_dpp v25, v22, v22 row_ror:8 row_mask:0xf bank_mask:0x3
  s_nop 1
  v_add_f32_dpp v25, v23, v23 row_ror:8 row_mask:0xf bank_mask:0xc
  v_add_f32_dpp v26, v24, v24 row_half_mirror row_mask:0xf bank_mask:0x5
  s_nop 1
  v_add_f32_dpp v26, v25, v25 row_half_mirror row_mask:0xf bank_mask:0xa
  s_nop 1
  v_add_f32_dpp v26, v26, v26 quad_perm:[1,0,3,2] row_mask:0xf bank_mask:0xf
  s_nop 1
  v_add_f32_dpp v26, v26, v26 quad_perm:[2,3,0,1] row_mask:0xf bank_mask:0xf
  v_cndmask_b32 v14, v14, v26, s[50:51]
  s_waitcnt vmcnt(4)
  s_mov_b32 s88, 688128
  buffer_load_dwordx4 v[64:67], v4, s[36:39], s88 offen offset:0 nt
  s_waitcnt vmcnt(4)
  buffer_load_dwordx4 v[68:71], v4, s[36:39], s88 offen offset:1024 nt
  v_dot2_f32_bf16 v20, v80, v8, 0
  v_dot2_f32_bf16 v21, v84, v8, 0
  v_dot2_f32_bf16 v22, v88, v8, 0
  v_dot2_f32_bf16 v23, v92, v8, 0
  v_dot2c_f32_bf16 v20, v81, v9
  v_dot2c_f32_bf16 v21, v85, v9
  v_dot2c_f32_bf16 v22, v89, v9
  v_dot2c_f32_bf16 v23, v93, v9
  v_dot2c_f32_bf16 v20, v82, v10
  v_dot2c_f32_bf16 v21, v86, v10
  v_dot2c_f32_bf16 v22, v90, v10
  v_dot2c_f32_bf16 v23, v94, v10
  v_dot2c_f32_bf16 v20, v83, v11
  v_dot2c_f32_bf16 v21, v87, v11
  v_dot2c_f32_bf16 v22, v91, v11
  v_dot2c_f32_bf16 v23, v95, v11
  v_add_f32_dpp v24, v20, v20 row_ror:8 row_mask:0xf bank_mask:0x3
  s_nop 1
  v_add_f32_dpp v24, v21, v21 row_ror:8 row_mask:0xf bank_mask:0xc
  v_add_f32_dpp v25, v22, v22 row_ror:8 row_mask:0xf bank_mask:0x3
  s_nop 1
  v_add_f32_dpp v25, v23, v23 row_ror:8 row_mask:0xf bank_mask:0xc
  v_add_f32_dpp v26, v24, v24 row_half_mirror row_mask:0xf bank_mask:0x5
  s_nop 1
  v_add_f32_dpp v26, v25, v25 row_half_mirror row_mask:0xf bank_mask:0xa
  s_nop 1
  v_add_f32_dpp v26, v26, v26 quad_perm:[1,0,3,2] row_mask:0xf bank_mask:0xf
  s_nop 1
  v_add_f32_dpp v26, v26, v26 quad_perm:[2,3,0,1] row_mask:0xf bank_mask:0xf
  v_cndmask_b32 v14, v14, v26, s[52:53]
  s_waitcnt vmcnt(4)
  buffer_load_dwordx4 v[72:75], v4, s[36:39], s88 offen offset:2048 nt
  ds_read_b128 v[80:83], v7 offset:0
  ds_read_b128 v[84:87], v7 offset:1024
  ds_read_b128 v[88:91], v7 offset:2048
  ds_read_b128 v[92:95], v7 offset:3072
  s_waitcnt lgkmcnt(0)
  v_dot2_f32_bf16 v20, v80, v8, 0
  v_dot2_f32_bf16 v21, v84, v8, 0
  v_dot2_f32_bf16 v22, v88, v8, 0
  v_dot2_f32_bf16 v23, v92, v8, 0
  v_dot2c_f32_bf16 v20, v81, v9
  v_dot2c_f32_bf16 v21, v85, v9
  v_dot2c_f32_bf16 v22, v89, v9
  v_dot2c_f32_bf16 v23, v93, v9
  v_dot2c_f32_bf16 v20, v82, v10
  v_dot2c_f32_bf16 v21, v86, v10
  v_dot2c_f32_bf16 v22, v90, v10
  v_dot2c_f32_bf16 v23, v94, v10
  v_dot2c_f32_bf16 v20, v83, v11
  v_dot2c_f32_bf16 v21, v87, v11
  v_dot2c_f32_bf16 v22, v91, v11
  v_dot2c_f32_bf16 v23, v95, v11
  v_add_f32_dpp v24, v20, v20 row_ror:8 row_mask:0xf bank_mask:0x3
  s_nop 1
  v_add_f32_dpp v24, v21, v21 row_ror:8 row_mask:0xf bank_mask:0xc
  v_add_f32_dpp v25, v22, v22 row_ror:8 row_mask:0xf bank_mask:0x3
  s_nop 1
  v_add_f32_dpp v25, v23, v23 row_ror:8 row_mask:0xf bank_mask:0xc
  v_add_f32_dpp v26, v24, v24 row_half_mirror row_mask:0xf bank_mask:0x5
  s_nop 1
  v_add_f32_dpp v26, v25, v25 row_half_mirror row_mask:0xf bank_mask:0xa
  s_nop 1
  v_add_f32_dpp v26, v26, v26 quad_perm:[1,0,3,2] row_mask:0xf bank_mask:0xf
  s_nop 1
  v_add_f32_dpp v12, v26, v26 quad_perm:[2,3,0,1] row_mask:0xf bank_mask:0xf
  s_waitcnt vmcnt(4)
  buffer_load_dwordx4 v[76:79], v4, s[36:39], s88 offen offset:3072 nt
  s_waitcnt vmcnt(4)
  s_mov_b32 s88, 704512
  buffer_load_dwordx4 v[80:83], v4, s[36:39], s88 offen offset:0 nt
  v_dot2_f32_bf16 v20, v96, v8, 0
  v_dot2_f32_bf16 v21, v100, v8, 0
  v_dot2_f32_bf16 v22, v104, v8, 0
  v_dot2_f32_bf16 v23, v108, v8, 0
  v_dot2c_f32_bf16 v20, v97, v9
  v_dot2c_f32_bf16 v21, v101, v9
  v_dot2c_f32_bf16 v22, v105, v9
  v_dot2c_f32_bf16 v23, v109, v9
  v_dot2c_f32_bf16 v20, v98, v10
  v_dot2c_f32_bf16 v21, v102, v10
  v_dot2c_f32_bf16 v22, v106, v10
  v_dot2c_f32_bf16 v23, v110, v10
  v_dot2c_f32_bf16 v20, v99, v11
  v_dot2c_f32_bf16 v21, v103, v11
  v_dot2c_f32_bf16 v22, v107, v11
  v_dot2c_f32_bf16 v23, v111, v11
  v_add_f32_dpp v24, v20, v20 row_ror:8 row_mask:0xf bank_mask:0x3
  s_nop 1
  v_add_f32_dpp v24, v21, v21 row_ror:8 row_mask:0xf bank_mask:0xc
  v_add_f32_dpp v25, v22, v22 row_ror:8 row_mask:0xf bank_mask:0x3
  s_nop 1
  v_add_f32_dpp v25, v23, v23 row_ror:8 row_mask:0xf bank_mask:0xc
  v_add_f32_dpp v26, v24, v24 row_half_mirror row_mask:0xf bank_mask:0x5
  s_nop 1
  v_add_f32_dpp v26, v25, v25 row_half_mirror row_mask:0xf bank_mask:0xa
  s_nop 1
  v_add_f32_dpp v26, v26, v26 quad_perm:[1,0,3,2] row_mask:0xf bank_mask:0xf
  s_nop 1
  v_add_f32_dpp v26, v26, v26 quad_perm:[2,3,0,1] row_mask:0xf bank_mask:0xf
  v_cndmask_b32 v14, v14, v26, s[54:55]
  s_waitcnt vmcnt(4)
  buffer_load_dwordx4 v[84:87], v4, s[36:39], s88 offen offset:1024 nt
  ds_read_b128 v[96:99], v7 offset:4096
  ds_read_b128 v[100:103], v7 offset:5120
  ds_read_b128 v[104:107], v7 offset:6144
  ds_read_b128 v[108:111], v7 offset:7168
  s_waitcnt lgkmcnt(0)
  v_dot2_f32_bf16 v20, v96, v8, 0
  v_dot2_f32_bf16 v21, v100, v8, 0
  v_dot2_f32_bf16 v22, v104, v8, 0
  v_dot2_f32_bf16 v23, v108, v8, 0
  v_dot2c_f32_bf16 v20, v97, v9
  v_dot2c_f32_bf16 v21, v101, v9
  v_dot2c_f32_bf16 v22, v105, v9
  v_dot2c_f32_bf16 v23, v109, v9
  v_dot2c_f32_bf16 v20, v98, v10
  v_dot2c_f32_bf16 v21, v102, v10
  v_dot2c_f32_bf16 v22, v106, v10
  v_dot2c_f32_bf16 v23, v110, v10
  v_dot2c_f32_bf16 v20, v99, v11
  v_dot2c_f32_bf16 v21, v103, v11
  v_dot2c_f32_bf16 v22, v107, v11
  v_dot2c_f32_bf16 v23, v111, v11
  v_add_f32_dpp v24, v20, v20 row_ror:8 row_mask:0xf bank_mask:0x3
  s_nop 1
  v_add_f32_dpp v24, v21, v21 row_ror:8 row_mask:0xf bank_mask:0xc
  v_add_f32_dpp v25, v22, v22 row_ror:8 row_mask:0xf bank_mask:0x3
  s_nop 1
  v_add_f32_dpp v25, v23, v23 row_ror:8 row_mask:0xf bank_mask:0xc
  v_add_f32_dpp v26, v24, v24 row_half_mirror row_mask:0xf bank_mask:0x5
  s_nop 1
  v_add_f32_dpp v26, v25, v25 row_half_mirror row_mask:0xf bank_mask:0xa
  s_nop 1
  v_add_f32_dpp v26, v26, v26 quad_perm:[1,0,3,2] row_mask:0xf bank_mask:0xf
  s_nop 1
  v_add_f32_dpp v26, v26, v26 quad_perm:[2,3,0,1] row_mask:0xf bank_mask:0xf
  v_cndmask_b32 v12, v12, v26, s[50:51]
  s_waitcnt vmcnt(4)
  buffer_load_dwordx4 v[88:91], v4, s[36:39], s88 offen offset:2048 nt
  ds_read_b128 v[96:99], v7 offset:8192
  ds_read_b128 v[100:103], v7 offset:9216
  ds_read_b128 v[104:107], v7 offset:10240
  ds_read_b128 v[108:111], v7 offset:11264
  s_waitcnt lgkmcnt(0)
  v_dot2_f32_bf16 v20, v96, v8, 0
  v_dot2_f32_bf16 v21, v100, v8, 0
  v_dot2_f32_bf16 v22, v104, v8, 0
  v_dot2_f32_bf16 v23, v108, v8, 0
  v_dot2c_f32_bf16 v20, v97, v9
  v_dot2c_f32_bf16 v21, v101, v9
  v_dot2c_f32_bf16 v22, v105, v9
  v_dot2c_f32_bf16 v23, v109, v9
  v_dot2c_f32_bf16 v20, v98, v10
  v_dot2c_f32_bf16 v21, v102, v10
  v_dot2c_f32_bf16 v22, v106, v10
  v_dot2c_f32_bf16 v23, v110, v10
  v_dot2c_f32_bf16 v20, v99, v11
  v_dot2c_f32_bf16 v21, v103, v11
  v_dot2c_f32_bf16 v22, v107, v11
  v_dot2c_f32_bf16 v23, v111, v11
  v_add_f32_dpp v24, v20, v20 row_ror:8 row_mask:0xf bank_mask:0x3
  s_nop 1
  v_add_f32_dpp v24, v21, v21 row_ror:8 row_mask:0xf bank_mask:0xc
  v_add_f32_dpp v25, v22, v22 row_ror:8 row_mask:0xf bank_mask:0x3
  s_nop 1
  v_add_f32_dpp v25, v23, v23 row_ror:8 row_mask:0xf bank_mask:0xc
  v_add_f32_dpp v26, v24, v24 row_half_mirror row_mask:0xf bank_mask:0x5
  s_nop 1
  v_add_f32_dpp v26, v25, v25 row_half_mirror row_mask:0xf bank_mask:0xa
  s_nop 1
  v_add_f32_dpp v26, v26, v26 quad_perm:[1,0,3,2] row_mask:0xf bank_mask:0xf
  s_nop 1
  v_add_f32_dpp v26, v26, v26 quad_perm:[2,3,0,1] row_mask:0xf bank_mask:0xf
  v_cndmask_b32 v12, v12, v26, s[52:53]
  s_waitcnt vmcnt(4)
  buffer_load_dwordx4 v[92:95], v4, s[36:39], s88 offen offset:3072 nt
  s_waitcnt vmcnt(4)
  s_mov_b32 s88, 786432
  buffer_load_dwordx4 v[96:99], v4, s[36:39], s88 offen offset:0 nt
  v_dot2_f32_bf16 v20, v112, v8, 0
  v_dot2_f32_bf16 v21, v116, v8, 0
  v_dot2_f32_bf16 v22, v120, v8, 0
  v_dot2_f32_bf16 v23, v124, v8, 0
  v_dot2c_f32_bf16 v20, v113, v9
  v_dot2c_f32_bf16 v21, v117, v9
  v_dot2c_f32_bf16 v22, v121, v9
  v_dot2c_f32_bf16 v23, v125, v9
  v_dot2c_f32_bf16 v20, v114, v10
  v_dot2c_f32_bf16 v21, v118, v10
  v_dot2c_f32_bf16 v22, v122, v10
  v_dot2c_f32_bf16 v23, v126, v10
  v_dot2c_f32_bf16 v20, v115, v11
  v_dot2c_f32_bf16 v21, v119, v11
  v_dot2c_f32_bf16 v22, v123, v11
  v_dot2c_f32_bf16 v23, v127, v11
  v_add_f32_dpp v24, v20, v20 row_ror:8 row_mask:0xf bank_mask:0x3
  s_nop 1
  v_add_f32_dpp v24, v21, v21 row_ror:8 row_mask:0xf bank_mask:0xc
  v_add_f32_dpp v25, v22, v22 row_ror:8 row_mask:0xf bank_mask:0x3
  s_nop 1
  v_add_f32_dpp v25, v23, v23 row_ror:8 row_mask:0xf bank_mask:0xc
  v_add_f32_dpp v26, v24, v24 row_half_mirror row_mask:0xf bank_mask:0x5
  s_nop 1
  v_add_f32_dpp v26, v25, v25 row_half_mirror row_mask:0xf bank_mask:0xa
  s_nop 1
  v_add_f32_dpp v26, v26, v26 quad_perm:[1,0,3,2] row_mask:0xf bank_mask:0xf
  s_nop 1
  v_add_f32_dpp v15, v26, v26 quad_perm:[2,3,0,1] row_mask:0xf bank_mask:0xf
  s_waitcnt vmcnt(4)
  buffer_load_dwordx4 v[100:103], v4, s[36:39], s88 offen offset:1024 nt
  ds_read_b128 v[112:115], v7 offset:12288
  ds_read_b128 v[116:119], v7 offset:13312
  ds_read_b128 v[120:123], v7 offset:14336
  ds_read_b128 v[124:127], v7 offset:15360
  s_waitcnt lgkmcnt(0)
  v_dot2_f32_bf16 v20, v112, v8, 0
  v_dot2_f32_bf16 v21, v116, v8, 0
  v_dot2_f32_bf16 v22, v120, v8, 0
  v_dot2_f32_bf16 v23, v124, v8, 0
  v_dot2c_f32_bf16 v20, v113, v9
  v_dot2c_f32_bf16 v21, v117, v9
  v_dot2c_f32_bf16 v22, v121, v9
  v_dot2c_f32_bf16 v23, v125, v9
  v_dot2c_f32_bf16 v20, v114, v10
  v_dot2c_f32_bf16 v21, v118, v10
  v_dot2c_f32_bf16 v22, v122, v10
  v_dot2c_f32_bf16 v23, v126, v10
  v_dot2c_f32_bf16 v20, v115, v11
  v_dot2c_f32_bf16 v21, v119, v11
  v_dot2c_f32_bf16 v22, v123, v11
  v_dot2c_f32_bf16 v23, v127, v11
  v_add_f32_dpp v24, v20, v20 row_ror:8 row_mask:0xf bank_mask:0x3
  s_nop 1
  v_add_f32_dpp v24, v21, v21 row_ror:8 row_mask:0xf bank_mask:0xc
  v_add_f32_dpp v25, v22, v22 row_ror:8 row_mask:0xf bank_mask:0x3
  s_nop 1
  v_add_f32_dpp v25, v23, v23 row_ror:8 row_mask:0xf bank_mask:0xc
  v_add_f32_dpp v26, v24, v24 row_half_mirror row_mask:0xf bank_mask:0x5
  s_nop 1
  v_add_f32_dpp v26, v25, v25 row_half_mirror row_mask:0xf bank_mask:0xa
  s_nop 1
  v_add_f32_dpp v26, v26, v26 quad_perm:[1,0,3,2] row_mask:0xf bank_mask:0xf
  s_nop 1
  v_add_f32_dpp v26, v26, v26 quad_perm:[2,3,0,1] row_mask:0xf bank_mask:0xf
  v_cndmask_b32 v12, v12, v26, s[54:55]
  s_waitcnt vmcnt(4)
  buffer_load_dwordx4 v[104:107], v4, s[36:39], s88 offen offset:2048 nt
  ds_read_b128 v[112:115], v7 offset:16384
  ds_read_b128 v[116:119], v7 offset:17408
  ds_read_b128 v[120:123], v7 offset:18432
  ds_read_b128 v[124:127], v7 offset:19456
  s_waitcnt lgkmcnt(0)
  v_dot2_f32_bf16 v20, v112, v8, 0
  v_dot2_f32_bf16 v21, v116, v8, 0
  v_dot2_f32_bf16 v22, v120, v8, 0
  v_dot2_f32_bf16 v23, v124, v8, 0
  v_dot2c_f32_bf16 v20, v113, v9
  v_dot2c_f32_bf16 v21, v117, v9
  v_dot2c_f32_bf16 v22, v121, v9
  v_dot2c_f32_bf16 v23, v125, v9
  v_dot2c_f32_bf16 v20, v114, v10
  v_dot2c_f32_bf16 v21, v118, v10
  v_dot2c_f32_bf16 v22, v122, v10
  v_dot2c_f32_bf16 v23, v126, v10
  v_dot2c_f32_bf16 v20, v115, v11
  v_dot2c_f32_bf16 v21, v119, v11
  v_dot2c_f32_bf16 v22, v123, v11
  v_dot2c_f32_bf16 v23, v127, v11
  v_add_f32_dpp v24, v20, v20 row_ror:8 row_mask:0xf bank_mask:0x3
  s_nop 1
  v_add_f32_dpp v24, v21, v21 row_ror:8 row_mask:0xf bank_mask:0xc
  v_add_f32_dpp v25, v22, v22 row_ror:8 row_mask:0xf bank_mask:0x3
  s_nop 1
  v_add_f32_dpp v25, v23, v23 row_ror:8 row_mask:0xf bank_mask:0xc
  v_add_f32_dpp v26, v24, v24 row_half_mirror row_mask:0xf bank_mask:0x5
  s_nop 1
  v_add_f32_dpp v26, v25, v25 row_half_mirror row_mask:0xf bank_mask:0xa
  s_nop 1
  v_add_f32_dpp v26, v26, v26 quad_perm:[1,0,3,2] row_mask:0xf bank_mask:0xf
  s_nop 1
  v_add_f32_dpp v13, v26, v26 quad_perm:[2,3,0,1] row_mask:0xf bank_mask:0xf
  s_waitcnt vmcnt(4)
  buffer_load_dwordx4 v[108:111], v4, s[36:39], s88 offen offset:3072 nt
  s_waitcnt vmcnt(4)
  s_mov_b32 s88, 802816
  buffer_load_dwordx4 v[112:115], v4, s[36:39], s88 offen offset:0 nt
  v_dot2_f32_bf16 v20, v128, v8, 0
  v_dot2_f32_bf16 v21, v132, v8, 0
  v_dot2_f32_bf16 v22, v136, v8, 0
  v_dot2_f32_bf16 v23, v140, v8, 0
  v_dot2c_f32_bf16 v20, v129, v9
  v_dot2c_f32_bf16 v21, v133, v9
  v_dot2c_f32_bf16 v22, v137, v9
  v_dot2c_f32_bf16 v23, v141, v9
  v_dot2c_f32_bf16 v20, v130, v10
  v_dot2c_f32_bf16 v21, v134, v10
  v_dot2c_f32_bf16 v22, v138, v10
  v_dot2c_f32_bf16 v23, v142, v10
  v_dot2c_f32_bf16 v20, v131, v11
  v_dot2c_f32_bf16 v21, v135, v11
  v_dot2c_f32_bf16 v22, v139, v11
  v_dot2c_f32_bf16 v23, v143, v11
  v_add_f32_dpp v24, v20, v20 row_ror:8 row_mask:0xf bank_mask:0x3
  s_nop 1
  v_add_f32_dpp v24, v21, v21 row_ror:8 row_mask:0xf bank_mask:0xc
  v_add_f32_dpp v25, v22, v22 row_ror:8 row_mask:0xf bank_mask:0x3
  s_nop 1
  v_add_f32_dpp v25, v23, v23 row_ror:8 row_mask:0xf bank_mask:0xc
  v_add_f32_dpp v26, v24, v24 row_half_mirror row_mask:0xf bank_mask:0x5
  s_nop 1
  v_add_f32_dpp v26, v25, v25 row_half_mirror row_mask:0xf bank_mask:0xa
  s_nop 1
  v_add_f32_dpp v26, v26, v26 quad_perm:[1,0,3,2] row_mask:0xf bank_mask:0xf
  s_nop 1
  v_add_f32_dpp v26, v26, v26 quad_perm:[2,3,0,1] row_mask:0xf bank_mask:0xf
  v_cndmask_b32 v15, v15, v26, s[50:51]
  s_waitcnt vmcnt(4)
  buffer_load_dwordx4 v[116:119], v4, s[36:39], s88 offen offset:1024 nt
  ds_read_b128 v[128:131], v7 offset:20480
  ds_read_b128 v[132:135], v7 offset:21504
  ds_read_b128 v[136:139], v7 offset:22528
  ds_read_b128 v[140:143], v7 offset:23552
  s_waitcnt lgkmcnt(0)
  v_dot2_f32_bf16 v20, v128, v8, 0
  v_dot2_f32_bf16 v21, v132, v8, 0
  v_dot2_f32_bf16 v22, v136, v8, 0
  v_dot2_f32_bf16 v23, v140, v8, 0
  v_dot2c_f32_bf16 v20, v129, v9
  v_dot2c_f32_bf16 v21, v133, v9
  v_dot2c_f32_bf16 v22, v137, v9
  v_dot2c_f32_bf16 v23, v141, v9
  v_dot2c_f32_bf16 v20, v130, v10
  v_dot2c_f32_bf16 v21, v134, v10
  v_dot2c_f32_bf16 v22, v138, v10
  v_dot2c_f32_bf16 v23, v142, v10
  v_dot2c_f32_bf16 v20, v131, v11
  v_dot2c_f32_bf16 v21, v135, v11
  v_dot2c_f32_bf16 v22, v139, v11
  v_dot2c_f32_bf16 v23, v143, v11
  v_add_f32_dpp v24, v20, v20 row_ror:8 row_mask:0xf bank_mask:0x3
  s_nop 1
  v_add_f32_dpp v24, v21, v21 row_ror:8 row_mask:0xf bank_mask:0xc
  v_add_f32_dpp v25, v22, v22 row_ror:8 row_mask:0xf bank_mask:0x3
  s_nop 1
  v_add_f32_dpp v25, v23, v23 row_ror:8 row_mask:0xf bank_mask:0xc
  v_add_f32_dpp v26, v24, v24 row_half_mirror row_mask:0xf bank_mask:0x5
  s_nop 1
  v_add_f32_dpp v26, v25, v25 row_half_mirror row_mask:0xf bank_mask:0xa
  s_nop 1
  v_add_f32_dpp v26, v26, v26 quad_perm:[1,0,3,2] row_mask:0xf bank_mask:0xf
  s_nop 1
  v_add_f32_dpp v26, v26, v26 quad_perm:[2,3,0,1] row_mask:0xf bank_mask:0xf
  v_cndmask_b32 v13, v13, v26, s[50:51]
  s_waitcnt vmcnt(4)
  buffer_load_dwordx4 v[120:123], v4, s[36:39], s88 offen offset:2048 nt
  ds_read_b128 v[128:131], v7 offset:24576
  ds_read_b128 v[132:135], v7 offset:25600
  ds_read_b128 v[136:139], v7 offset:26624
  ds_read_b128 v[140:143], v7 offset:27648
  s_waitcnt lgkmcnt(0)
  v_dot2_f32_bf16 v20, v128, v8, 0
  v_dot2_f32_bf16 v21, v132, v8, 0
  v_dot2_f32_bf16 v22, v136, v8, 0
  v_dot2_f32_bf16 v23, v140, v8, 0
  v_dot2c_f32_bf16 v20, v129, v9
  v_dot2c_f32_bf16 v21, v133, v9
  v_dot2c_f32_bf16 v22, v137, v9
  v_dot2c_f32_bf16 v23, v141, v9
  v_dot2c_f32_bf16 v20, v130, v10
  v_dot2c_f32_bf16 v21, v134, v10
  v_dot2c_f32_bf16 v22, v138, v10
  v_dot2c_f32_bf16 v23, v142, v10
  v_dot2c_f32_bf16 v20, v131, v11
  v_dot2c_f32_bf16 v21, v135, v11
  v_dot2c_f32_bf16 v22, v139, v11
  v_dot2c_f32_bf16 v23, v143, v11
  v_add_f32_dpp v24, v20, v20 row_ror:8 row_mask:0xf bank_mask:0x3
  s_nop 1
  v_add_f32_dpp v24, v21, v21 row_ror:8 row_mask:0xf bank_mask:0xc
  v_add_f32_dpp v25, v22, v22 row_ror:8 row_mask:0xf bank_mask:0x3
  s_nop 1
  v_add_f32_dpp v25, v23, v23 row_ror:8 row_mask:0xf bank_mask:0xc
  v_add_f32_dpp v26, v24, v24 row_half_mirror row_mask:0xf bank_mask:0x5
  s_nop 1
  v_add_f32_dpp v26, v25, v25 row_half_mirror row_mask:0xf bank_mask:0xa
  s_nop 1
  v_add_f32_dpp v26, v26, v26 quad_perm:[1,0,3,2] row_mask:0xf bank_mask:0xf
  s_nop 1
  v_add_f32_dpp v26, v26, v26 quad_perm:[2,3,0,1] row_mask:0xf bank_mask:0xf
  v_cndmask_b32 v13, v13, v26, s[52:53]
  s_waitcnt vmcnt(4)
  buffer_load_dwordx4 v[124:127], v4, s[36:39], s88 offen offset:3072 nt
  s_waitcnt vmcnt(4)
  s_mov_b32 s88, 819200
  buffer_load_dwordx4 v[128:131], v4, s[36:39], s88 offen offset:0 nt
  v_dot2_f32_bf16 v20, v144, v8, 0
  v_dot2_f32_bf16 v21, v148, v8, 0
  v_dot2_f32_bf16 v22, v152, v8, 0
  v_dot2_f32_bf16 v23, v156, v8, 0
  v_dot2c_f32_bf16 v20, v145, v9
  v_dot2c_f32_bf16 v21, v149, v9
  v_dot2c_f32_bf16 v22, v153, v9
  v_dot2c_f32_bf16 v23, v157, v9
  v_dot2c_f32_bf16 v20, v146, v10
  v_dot2c_f32_bf16 v21, v150, v10
  v_dot2c_f32_bf16 v22, v154, v10
  v_dot2c_f32_bf16 v23, v158, v10
  v_dot2c_f32_bf16 v20, v147, v11
  v_dot2c_f32_bf16 v21, v151, v11
  v_dot2c_f32_bf16 v22, v155, v11
  v_dot2c_f32_bf16 v23, v159, v11
  v_add_f32_dpp v24, v20, v20 row_ror:8 row_mask:0xf bank_mask:0x3
  s_nop 1
  v_add_f32_dpp v24, v21, v21 row_ror:8 row_mask:0xf bank_mask:0xc
  v_add_f32_dpp v25, v22, v22 row_ror:8 row_mask:0xf bank_mask:0x3
  s_nop 1
  v_add_f32_dpp v25, v23, v23 row_ror:8 row_mask:0xf bank_mask:0xc
  v_add_f32_dpp v26, v24, v24 row_half_mirror row_mask:0xf bank_mask:0x5
  s_nop 1
  v_add_f32_dpp v26, v25, v25 row_half_mirror row_mask:0xf bank_mask:0xa
  s_nop 1
  v_add_f32_dpp v26, v26, v26 quad_perm:[1,0,3,2] row_mask:0xf bank_mask:0xf
  s_nop 1
  v_add_f32_dpp v26, v26, v26 quad_perm:[2,3,0,1] row_mask:0xf bank_mask:0xf
  v_cndmask_b32 v15, v15, v26, s[52:53]
  s_waitcnt vmcnt(4)
  buffer_load_dwordx4 v[132:135], v4, s[36:39], s88 offen offset:1024 nt
  ds_read_b128 v[144:147], v7 offset:28672
  ds_read_b128 v[148:151], v7 offset:29696
  ds_read_b128 v[152:155], v7 offset:30720
  ds_read_b128 v[156:159], v7 offset:31744
  s_waitcnt lgkmcnt(0)
  v_dot2_f32_bf16 v20, v144, v8, 0
  v_dot2_f32_bf16 v21, v148, v8, 0
  v_dot2_f32_bf16 v22, v152, v8, 0
  v_dot2_f32_bf16 v23, v156, v8, 0
  v_dot2c_f32_bf16 v20, v145, v9
  v_dot2c_f32_bf16 v21, v149, v9
  v_dot2c_f32_bf16 v22, v153, v9
  v_dot2c_f32_bf16 v23, v157, v9
  v_dot2c_f32_bf16 v20, v146, v10
  v_dot2c_f32_bf16 v21, v150, v10
  v_dot2c_f32_bf16 v22, v154, v10
  v_dot2c_f32_bf16 v23, v158, v10
  v_dot2c_f32_bf16 v20, v147, v11
  v_dot2c_f32_bf16 v21, v151, v11
  v_dot2c_f32_bf16 v22, v155, v11
  v_dot2c_f32_bf16 v23, v159, v11
  v_add_f32_dpp v24, v20, v20 row_ror:8 row_mask:0xf bank_mask:0x3
  s_nop 1
  v_add_f32_dpp v24, v21, v21 row_ror:8 row_mask:0xf bank_mask:0xc
  v_add_f32_dpp v25, v22, v22 row_ror:8 row_mask:0xf bank_mask:0x3
  s_nop 1
  v_add_f32_dpp v25, v23, v23 row_ror:8 row_mask:0xf bank_mask:0xc
  v_add_f32_dpp v26, v24, v24 row_half_mirror row_mask:0xf bank_mask:0x5
  s_nop 1
  v_add_f32_dpp v26, v25, v25 row_half_mirror row_mask:0xf bank_mask:0xa
  s_nop 1
  v_add_f32_dpp v26, v26, v26 quad_perm:[1,0,3,2] row_mask:0xf bank_mask:0xf
  s_nop 1
  v_add_f32_dpp v26, v26, v26 quad_perm:[2,3,0,1] row_mask:0xf bank_mask:0xf
  v_cndmask_b32 v13, v13, v26, s[54:55]
  s_waitcnt vmcnt(4)
  buffer_load_dwordx4 v[136:139], v4, s[36:39], s88 offen offset:2048 nt
  v_dot2_f32_bf16 v20, v160, v8, 0
  v_dot2_f32_bf16 v21, v164, v8, 0
  v_dot2_f32_bf16 v22, v168, v8, 0
  v_dot2_f32_bf16 v23, v172, v8, 0
  v_dot2c_f32_bf16 v20, v161, v9
  v_dot2c_f32_bf16 v21, v165, v9
  v_dot2c_f32_bf16 v22, v169, v9
  v_dot2c_f32_bf16 v23, v173, v9
  v_dot2c_f32_bf16 v20, v162, v10
  v_dot2c_f32_bf16 v21, v166, v10
  v_dot2c_f32_bf16 v22, v170, v10
  v_dot2c_f32_bf16 v23, v174, v10
  v_dot2c_f32_bf16 v20, v163, v11
  v_dot2c_f32_bf16 v21, v167, v11
  v_dot2c_f32_bf16 v22, v171, v11
  v_dot2c_f32_bf16 v23, v175, v11
  v_add_f32_dpp v24, v20, v20 row_ror:8 row_mask:0xf bank_mask:0x3
  s_nop 1
  v_add_f32_dpp v24, v21, v21 row_ror:8 row_mask:0xf bank_mask:0xc
  v_add_f32_dpp v25, v22, v22 row_ror:8 row_mask:0xf bank_mask:0x3
  s_nop 1
  v_add_f32_dpp v25, v23, v23 row_ror:8 row_mask:0xf bank_mask:0xc
  v_add_f32_dpp v26, v24, v24 row_half_mirror row_mask:0xf bank_mask:0x5
  s_nop 1
  v_add_f32_dpp v26, v25, v25 row_half_mirror row_mask:0xf bank_mask:0xa
  s_nop 1
  v_add_f32_dpp v26, v26, v26 quad_perm:[1,0,3,2] row_mask:0xf bank_mask:0xf
  s_nop 1
  v_add_f32_dpp v26, v26, v26 quad_perm:[2,3,0,1] row_mask:0xf bank_mask:0xf
  v_cndmask_b32 v15, v15, v26, s[54:55]
  s_waitcnt vmcnt(4)
  buffer_load_dwordx4 v[140:143], v4, s[36:39], s88 offen offset:3072 nt
  s_waitcnt vmcnt(4)
  s_mov_b32 s88, 835584
  buffer_load_dwordx4 v[144:147], v4, s[36:39], s88 offen offset:0 nt
  v_dot2_f32_bf16 v20, v176, v8, 0
  v_dot2_f32_bf16 v21, v180, v8, 0
  v_dot2_f32_bf16 v22, v184, v8, 0
  v_dot2_f32_bf16 v23, v188, v8, 0
  v_dot2c_f32_bf16 v20, v177, v9
  v_dot2c_f32_bf16 v21, v181, v9
  v_dot2c_f32_bf16 v22, v185, v9
  v_dot2c_f32_bf16 v23, v189, v9
  v_dot2c_f32_bf16 v20, v178, v10
  v_dot2c_f32_bf16 v21, v182, v10
  v_dot2c_f32_bf16 v22, v186, v10
  v_dot2c_f32_bf16 v23, v190, v10
  v_dot2c_f32_bf16 v20, v179, v11
  v_dot2c_f32_bf16 v21, v183, v11
  v_dot2c_f32_bf16 v22, v187, v11
  v_dot2c_f32_bf16 v23, v191, v11
  v_add_f32_dpp v24, v20, v20 row_ror:8 row_mask:0xf bank_mask:0x3
  s_nop 1
  v_add_f32_dpp v24, v21, v21 row_ror:8 row_mask:0xf bank_mask:0xc
  v_add_f32_dpp v25, v22, v22 row_ror:8 row_mask:0xf bank_mask:0x3
  s_nop 1
  v_add_f32_dpp v25, v23, v23 row_ror:8 row_mask:0xf bank_mask:0xc
  v_add_f32_dpp v26, v24, v24 row_half_mirror row_mask:0xf bank_mask:0x5
  s_nop 1
  v_add_f32_dpp v26, v25, v25 row_half_mirror row_mask:0xf bank_mask:0xa
  s_nop 1
  v_add_f32_dpp v26, v26, v26 quad_perm:[1,0,3,2] row_mask:0xf bank_mask:0xf
  s_nop 1
  v_add_f32_dpp v16, v26, v26 quad_perm:[2,3,0,1] row_mask:0xf bank_mask:0xf
  s_waitcnt vmcnt(4)
  buffer_load_dwordx4 v[148:151], v4, s[36:39], s88 offen offset:1024 nt
  v_dot2_f32_bf16 v20, v192, v8, 0
  v_dot2_f32_bf16 v21, v196, v8, 0
  v_dot2_f32_bf16 v22, v200, v8, 0
  v_dot2_f32_bf16 v23, v204, v8, 0
  v_dot2c_f32_bf16 v20, v193, v9
  v_dot2c_f32_bf16 v21, v197, v9
  v_dot2c_f32_bf16 v22, v201, v9
  v_dot2c_f32_bf16 v23, v205, v9
  v_dot2c_f32_bf16 v20, v194, v10
  v_dot2c_f32_bf16 v21, v198, v10
  v_dot2c_f32_bf16 v22, v202, v10
  v_dot2c_f32_bf16 v23, v206, v10
  v_dot2c_f32_bf16 v20, v195, v11
  v_dot2c_f32_bf16 v21, v199, v11
  v_dot2c_f32_bf16 v22, v203, v11
  v_dot2c_f32_bf16 v23, v207, v11
  v_add_f32_dpp v24, v20, v20 row_ror:8 row_mask:0xf bank_mask:0x3
  s_nop 1
  v_add_f32_dpp v24, v21, v21 row_ror:8 row_mask:0xf bank_mask:0xc
  v_add_f32_dpp v25, v22, v22 row_ror:8 row_mask:0xf bank_mask:0x3
  s_nop 1
  v_add_f32_dpp v25, v23, v23 row_ror:8 row_mask:0xf bank_mask:0xc
  v_add_f32_dpp v26, v24, v24 row_half_mirror row_mask:0xf bank_mask:0x5
  s_nop 1
  v_add_f32_dpp v26, v25, v25 row_half_mirror row_mask:0xf bank_mask:0xa
  s_nop 1
  v_add_f32_dpp v26, v26, v26 quad_perm:[1,0,3,2] row_mask:0xf bank_mask:0xf
  s_nop 1
  v_add_f32_dpp v26, v26, v26 quad_perm:[2,3,0,1] row_mask:0xf bank_mask:0xf
  v_cndmask_b32 v16, v16, v26, s[50:51]
  s_waitcnt vmcnt(4)
  buffer_load_dwordx4 v[152:155], v4, s[36:39], s88 offen offset:2048 nt
  v_dot2_f32_bf16 v20, v208, v8, 0
  v_dot2_f32_bf16 v21, v212, v8, 0
  v_dot2_f32_bf16 v22, v216, v8, 0
  v_dot2_f32_bf16 v23, v220, v8, 0
  v_dot2c_f32_bf16 v20, v209, v9
  v_dot2c_f32_bf16 v21, v213, v9
  v_dot2c_f32_bf16 v22, v217, v9
  v_dot2c_f32_bf16 v23, v221, v9
  v_dot2c_f32_bf16 v20, v210, v10
  v_dot2c_f32_bf16 v21, v214, v10
  v_dot2c_f32_bf16 v22, v218, v10
  v_dot2c_f32_bf16 v23, v222, v10
  v_dot2c_f32_bf16 v20, v211, v11
  v_dot2c_f32_bf16 v21, v215, v11
  v_dot2c_f32_bf16 v22, v219, v11
  v_dot2c_f32_bf16 v23, v223, v11
  v_add_f32_dpp v24, v20, v20 row_ror:8 row_mask:0xf bank_mask:0x3
  s_nop 1
  v_add_f32_dpp v24, v21, v21 row_ror:8 row_mask:0xf bank_mask:0xc
  v_add_f32_dpp v25, v22, v22 row_ror:8 row_mask:0xf bank_mask:0x3
  s_nop 1
  v_add_f32_dpp v25, v23, v23 row_ror:8 row_mask:0xf bank_mask:0xc
  v_add_f32_dpp v26, v24, v24 row_half_mirror row_mask:0xf bank_mask:0x5
  s_nop 1
  v_add_f32_dpp v26, v25, v25 row_half_mirror row_mask:0xf bank_mask:0xa
  s_nop 1
  v_add_f32_dpp v26, v26, v26 quad_perm:[1,0,3,2] row_mask:0xf bank_mask:0xf
  s_nop 1
  v_add_f32_dpp v26, v26, v26 quad_perm:[2,3,0,1] row_mask:0xf bank_mask:0xf
  v_cndmask_b32 v16, v16, v26, s[52:53]
  s_waitcnt vmcnt(4)
  buffer_load_dwordx4 v[156:159], v4, s[36:39], s88 offen offset:3072 nt
  s_waitcnt vmcnt(4)
  s_mov_b32 s88, 917504
  buffer_load_dwordx4 v[160:163], v4, s[36:39], s88 offen offset:0 nt
  v_dot2_f32_bf16 v20, v224, v8, 0
  v_dot2_f32_bf16 v21, v228, v8, 0
  v_dot2_f32_bf16 v22, v232, v8, 0
  v_dot2_f32_bf16 v23, v236, v8, 0
  v_dot2c_f32_bf16 v20, v225, v9
  v_dot2c_f32_bf16 v21, v229, v9
  v_dot2c_f32_bf16 v22, v233, v9
  v_dot2c_f32_bf16 v23, v237, v9
  v_dot2c_f32_bf16 v20, v226, v10
  v_dot2c_f32_bf16 v21, v230, v10
  v_dot2c_f32_bf16 v22, v234, v10
  v_dot2c_f32_bf16 v23, v238, v10
  v_dot2c_f32_bf16 v20, v227, v11
  v_dot2c_f32_bf16 v21, v231, v11
  v_dot2c_f32_bf16 v22, v235, v11
  v_dot2c_f32_bf16 v23, v239, v11
  v_add_f32_dpp v24, v20, v20 row_ror:8 row_mask:0xf bank_mask:0x3
  s_nop 1
  v_add_f32_dpp v24, v21, v21 row_ror:8 row_mask:0xf bank_mask:0xc
  v_add_f32_dpp v25, v22, v22 row_ror:8 row_mask:0xf bank_mask:0x3
  s_nop 1
  v_add_f32_dpp v25, v23, v23 row_ror:8 row_mask:0xf bank_mask:0xc
  v_add_f32_dpp v26, v24, v24 row_half_mirror row_mask:0xf bank_mask:0x5
  s_nop 1
  v_add_f32_dpp v26, v25, v25 row_half_mirror row_mask:0xf bank_mask:0xa
  s_nop 1
  v_add_f32_dpp v26, v26, v26 quad_perm:[1,0,3,2] row_mask:0xf bank_mask:0xf
  s_nop 1
  v_add_f32_dpp v26, v26, v26 quad_perm:[2,3,0,1] row_mask:0xf bank_mask:0xf
  v_cndmask_b32 v16, v16, v26, s[54:55]
  s_waitcnt vmcnt(4)
  buffer_load_dwordx4 v[164:167], v4, s[36:39], s88 offen offset:1024 nt
  v_dot2_f32_bf16 v20, v240, v8, 0
  v_dot2_f32_bf16 v21, v244, v8, 0
  v_dot2_f32_bf16 v22, v248, v8, 0
  v_dot2_f32_bf16 v23, v252, v8, 0
  v_dot2c_f32_bf16 v20, v241, v9
  v_dot2c_f32_bf16 v21, v245, v9
  v_dot2c_f32_bf16 v22, v249, v9
  v_dot2c_f32_bf16 v23, v253, v9
  v_dot2c_f32_bf16 v20, v242, v10
  v_dot2c_f32_bf16 v21, v246, v10
  v_dot2c_f32_bf16 v22, v250, v10
  v_dot2c_f32_bf16 v23, v254, v10
  v_dot2c_f32_bf16 v20, v243, v11
  v_dot2c_f32_bf16 v21, v247, v11
  v_dot2c_f32_bf16 v22, v251, v11
  v_dot2c_f32_bf16 v23, v255, v11
  v_add_f32_dpp v24, v20, v20 row_ror:8 row_mask:0xf bank_mask:0x3
  s_nop 1
  v_add_f32_dpp v24, v21, v21 row_ror:8 row_mask:0xf bank_mask:0xc
  v_add_f32_dpp v25, v22, v22 row_ror:8 row_mask:0xf bank_mask:0x3
  s_nop 1
  v_add_f32_dpp v25, v23, v23 row_ror:8 row_mask:0xf bank_mask:0xc
  v_add_f32_dpp v26, v24, v24 row_half_mirror row_mask:0xf bank_mask:0x5
  s_nop 1
  v_add_f32_dpp v26, v25, v25 row_half_mirror row_mask:0xf bank_mask:0xa
  s_nop 1
  v_add_f32_dpp v26, v26, v26 quad_perm:[1,0,3,2] row_mask:0xf bank_mask:0xf
  s_nop 1
  v_add_f32_dpp v17, v26, v26 quad_perm:[2,3,0,1] row_mask:0xf bank_mask:0xf
  s_waitcnt vmcnt(4)
  buffer_load_dwordx4 v[168:171], v4, s[36:39], s88 offen offset:2048 nt
  v_dot2_f32_bf16 v20, v48, v8, 0
  v_dot2_f32_bf16 v21, v52, v8, 0
  v_dot2_f32_bf16 v22, v56, v8, 0
  v_dot2_f32_bf16 v23, v60, v8, 0
  v_dot2c_f32_bf16 v20, v49, v9
  v_dot2c_f32_bf16 v21, v53, v9
  v_dot2c_f32_bf16 v22, v57, v9
  v_dot2c_f32_bf16 v23, v61, v9
  v_dot2c_f32_bf16 v20, v50, v10
  v_dot2c_f32_bf16 v21, v54, v10
  v_dot2c_f32_bf16 v22, v58, v10
  v_dot2c_f32_bf16 v23, v62, v10
  v_dot2c_f32_bf16 v20, v51, v11
  v_dot2c_f32_bf16 v21, v55, v11
  v_dot2c_f32_bf16 v22, v59, v11
  v_dot2c_f32_bf16 v23, v63, v11
  v_add_f32_dpp v24, v20, v20 row_ror:8 row_mask:0xf bank_mask:0x3
  s_nop 1
  v_add_f32_dpp v24, v21, v21 row_ror:8 row_mask:0xf bank_mask:0xc
  v_add_f32_dpp v25, v22, v22 row_ror:8 row_mask:0xf bank_mask:0x3
  s_nop 1
  v_add_f32_dpp v25, v23, v23 row_ror:8 row_mask:0xf bank_mask:0xc
  v_add_f32_dpp v26, v24, v24 row_half_mirror row_mask:0xf bank_mask:0x5
  s_nop 1
  v_add_f32_dpp v26, v25, v25 row_half_mirror row_mask:0xf bank_mask:0xa
  s_nop 1
  v_add_f32_dpp v26, v26, v26 quad_perm:[1,0,3,2] row_mask:0xf bank_mask:0xf
  s_nop 1
  v_add_f32_dpp v26, v26, v26 quad_perm:[2,3,0,1] row_mask:0xf bank_mask:0xf
  v_cndmask_b32 v17, v17, v26, s[50:51]
  s_waitcnt vmcnt(4)
  buffer_load_dwordx4 v[172:175], v4, s[36:39], s88 offen offset:3072 nt
  s_waitcnt vmcnt(4)
  s_mov_b32 s88, 933888
  buffer_load_dwordx4 v[176:179], v4, s[36:39], s88 offen offset:0 nt
  v_dot2_f32_bf16 v20, v64, v8, 0
  v_dot2_f32_bf16 v21, v68, v8, 0
  v_dot2_f32_bf16 v22, v72, v8, 0
  v_dot2_f32_bf16 v23, v76, v8, 0
  v_dot2c_f32_bf16 v20, v65, v9
  v_dot2c_f32_bf16 v21, v69, v9
  v_dot2c_f32_bf16 v22, v73, v9
  v_dot2c_f32_bf16 v23, v77, v9
  v_dot2c_f32_bf16 v20, v66, v10
  v_dot2c_f32_bf16 v21, v70, v10
  v_dot2c_f32_bf16 v22, v74, v10
  v_dot2c_f32_bf16 v23, v78, v10
  v_dot2c_f32_bf16 v20, v67, v11
  v_dot2c_f32_bf16 v21, v71, v11
  v_dot2c_f32_bf16 v22, v75, v11
  v_dot2c_f32_bf16 v23, v79, v11
  v_add_f32_dpp v24, v20, v20 row_ror:8 row_mask:0xf bank_mask:0x3
  s_nop 1
  v_add_f32_dpp v24, v21, v21 row_ror:8 row_mask:0xf bank_mask:0xc
  v_add_f32_dpp v25, v22, v22 row_ror:8 row_mask:0xf bank_mask:0x3
  s_nop 1
  v_add_f32_dpp v25, v23, v23 row_ror:8 row_mask:0xf bank_mask:0xc
  v_add_f32_dpp v26, v24, v24 row_half_mirror row_mask:0xf bank_mask:0x5
  s_nop 1
  v_add_f32_dpp v26, v25, v25 row_half_mirror row_mask:0xf bank_mask:0xa
  s_nop 1
  v_add_f32_dpp v26, v26, v26 quad_perm:[1,0,3,2] row_mask:0xf bank_mask:0xf
  s_nop 1
  v_add_f32_dpp v26, v26, v26 quad_perm:[2,3,0,1] row_mask:0xf bank_mask:0xf
  v_cndmask_b32 v17, v17, v26, s[52:53]
  s_waitcnt vmcnt(4)
  buffer_load_dwordx4 v[180:183], v4, s[36:39], s88 offen offset:1024 nt
  v_dot2_f32_bf16 v20, v80, v8, 0
  v_dot2_f32_bf16 v21, v84, v8, 0
  v_dot2_f32_bf16 v22, v88, v8, 0
  v_dot2_f32_bf16 v23, v92, v8, 0
  v_dot2c_f32_bf16 v20, v81, v9
  v_dot2c_f32_bf16 v21, v85, v9
  v_dot2c_f32_bf16 v22, v89, v9
  v_dot2c_f32_bf16 v23, v93, v9
  v_dot2c_f32_bf16 v20, v82, v10
  v_dot2c_f32_bf16 v21, v86, v10
  v_dot2c_f32_bf16 v22, v90, v10
  v_dot2c_f32_bf16 v23, v94, v10
  v_dot2c_f32_bf16 v20, v83, v11
  v_dot2c_f32_bf16 v21, v87, v11
  v_dot2c_f32_bf16 v22, v91, v11
  v_dot2c_f32_bf16 v23, v95, v11
  v_add_f32_dpp v24, v20, v20 row_ror:8 row_mask:0xf bank_mask:0x3
  s_nop 1
  v_add_f32_dpp v24, v21, v21 row_ror:8 row_mask:0xf bank_mask:0xc
  v_add_f32_dpp v25, v22, v22 row_ror:8 row_mask:0xf bank_mask:0x3
  s_nop 1
  v_add_f32_dpp v25, v23, v23 row_ror:8 row_mask:0xf bank_mask:0xc
  v_add_f32_dpp v26, v24, v24 row_half_mirror row_mask:0xf bank_mask:0x5
  s_nop 1
  v_add_f32_dpp v26, v25, v25 row_half_mirror row_mask:0xf bank_mask:0xa
  s_nop 1
  v_add_f32_dpp v26, v26, v26 quad_perm:[1,0,3,2] row_mask:0xf bank_mask:0xf
  s_nop 1
  v_add_f32_dpp v26, v26, v26 quad_perm:[2,3,0,1] row_mask:0xf bank_mask:0xf
  v_cndmask_b32 v17, v17, v26, s[54:55]
  s_waitcnt vmcnt(4)
  buffer_load_dwordx4 v[184:187], v4, s[36:39], s88 offen offset:2048 nt
  v_dot2_f32_bf16 v20, v96, v8, 0
  v_dot2_f32_bf16 v21, v100, v8, 0
  v_dot2_f32_bf16 v22, v104, v8, 0
  v_dot2_f32_bf16 v23, v108, v8, 0
  v_dot2c_f32_bf16 v20, v97, v9
  v_dot2c_f32_bf16 v21, v101, v9
  v_dot2c_f32_bf16 v22, v105, v9
  v_dot2c_f32_bf16 v23, v109, v9
  v_dot2c_f32_bf16 v20, v98, v10
  v_dot2c_f32_bf16 v21, v102, v10
  v_dot2c_f32_bf16 v22, v106, v10
  v_dot2c_f32_bf16 v23, v110, v10
  v_dot2c_f32_bf16 v20, v99, v11
  v_dot2c_f32_bf16 v21, v103, v11
  v_dot2c_f32_bf16 v22, v107, v11
  v_dot2c_f32_bf16 v23, v111, v11
  v_add_f32_dpp v24, v20, v20 row_ror:8 row_mask:0xf bank_mask:0x3
  s_nop 1
  v_add_f32_dpp v24, v21, v21 row_ror:8 row_mask:0xf bank_mask:0xc
  v_add_f32_dpp v25, v22, v22 row_ror:8 row_mask:0xf bank_mask:0x3
  s_nop 1
  v_add_f32_dpp v25, v23, v23 row_ror:8 row_mask:0xf bank_mask:0xc
  v_add_f32_dpp v26, v24, v24 row_half_mirror row_mask:0xf bank_mask:0x5
  s_nop 1
  v_add_f32_dpp v26, v25, v25 row_half_mirror row_mask:0xf bank_mask:0xa
  s_nop 1
  v_add_f32_dpp v26, v26, v26 quad_perm:[1,0,3,2] row_mask:0xf bank_mask:0xf
  s_nop 1
  v_add_f32_dpp v18, v26, v26 quad_perm:[2,3,0,1] row_mask:0xf bank_mask:0xf
  s_waitcnt vmcnt(4)
  buffer_load_dwordx4 v[188:191], v4, s[36:39], s88 offen offset:3072 nt
  s_waitcnt vmcnt(4)
  s_mov_b32 s88, 950272
  buffer_load_dwordx4 v[192:195], v4, s[36:39], s88 offen offset:0 nt
  v_dot2_f32_bf16 v20, v112, v8, 0
  v_dot2_f32_bf16 v21, v116, v8, 0
  v_dot2_f32_bf16 v22, v120, v8, 0
  v_dot2_f32_bf16 v23, v124, v8, 0
  v_dot2c_f32_bf16 v20, v113, v9
  v_dot2c_f32_bf16 v21, v117, v9
  v_dot2c_f32_bf16 v22, v121, v9
  v_dot2c_f32_bf16 v23, v125, v9
  v_dot2c_f32_bf16 v20, v114, v10
  v_dot2c_f32_bf16 v21, v118, v10
  v_dot2c_f32_bf16 v22, v122, v10
  v_dot2c_f32_bf16 v23, v126, v10
  v_dot2c_f32_bf16 v20, v115, v11
  v_dot2c_f32_bf16 v21, v119, v11
  v_dot2c_f32_bf16 v22, v123, v11
  v_dot2c_f32_bf16 v23, v127, v11
  v_add_f32_dpp v24, v20, v20 row_ror:8 row_mask:0xf bank_mask:0x3
  s_nop 1
  v_add_f32_dpp v24, v21, v21 row_ror:8 row_mask:0xf bank_mask:0xc
  v_add_f32_dpp v25, v22, v22 row_ror:8 row_mask:0xf bank_mask:0x3
  s_nop 1
  v_add_f32_dpp v25, v23, v23 row_ror:8 row_mask:0xf bank_mask:0xc
  v_add_f32_dpp v26, v24, v24 row_half_mirror row_mask:0xf bank_mask:0x5
  s_nop 1
  v_add_f32_dpp v26, v25, v25 row_half_mirror row_mask:0xf bank_mask:0xa
  s_nop 1
  v_add_f32_dpp v26, v26, v26 quad_perm:[1,0,3,2] row_mask:0xf bank_mask:0xf
  s_nop 1
  v_add_f32_dpp v26, v26, v26 quad_perm:[2,3,0,1] row_mask:0xf bank_mask:0xf
  v_cndmask_b32 v18, v18, v26, s[50:51]
  s_waitcnt vmcnt(4)
  buffer_load_dwordx4 v[196:199], v4, s[36:39], s88 offen offset:1024 nt
  v_dot2_f32_bf16 v20, v128, v8, 0
  v_dot2_f32_bf16 v21, v132, v8, 0
  v_dot2_f32_bf16 v22, v136, v8, 0
  v_dot2_f32_bf16 v23, v140, v8, 0
  v_dot2c_f32_bf16 v20, v129, v9
  v_dot2c_f32_bf16 v21, v133, v9
  v_dot2c_f32_bf16 v22, v137, v9
  v_dot2c_f32_bf16 v23, v141, v9
  v_dot2c_f32_bf16 v20, v130, v10
  v_dot2c_f32_bf16 v21, v134, v10
  v_dot2c_f32_bf16 v22, v138, v10
  v_dot2c_f32_bf16 v23, v142, v10
  v_dot2c_f32_bf16 v20, v131, v11
  v_dot2c_f32_bf16 v21, v135, v11
  v_dot2c_f32_bf16 v22, v139, v11
  v_dot2c_f32_bf16 v23, v143, v11
  v_add_f32_dpp v24, v20, v20 row_ror:8 row_mask:0xf bank_mask:0x3
  s_nop 1
  v_add_f32_dpp v24, v21, v21 row_ror:8 row_mask:0xf bank_mask:0xc
  v_add_f32_dpp v25, v22, v22 row_ror:8 row_mask:0xf bank_mask:0x3
  s_nop 1
  v_add_f32_dpp v25, v23, v23 row_ror:8 row_mask:0xf bank_mask:0xc
  v_add_f32_dpp v26, v24, v24 row_half_mirror row_mask:0xf bank_mask:0x5
  s_nop 1
  v_add_f32_dpp v26, v25, v25 row_half_mirror row_mask:0xf bank_mask:0xa
  s_nop 1
  v_add_f32_dpp v26, v26, v26 quad_perm:[1,0,3,2] row_mask:0xf bank_mask:0xf
  s_nop 1
  v_add_f32_dpp v26, v26, v26 quad_perm:[2,3,0,1] row_mask:0xf bank_mask:0xf
  v_cndmask_b32 v18, v18, v26, s[52:53]
  s_waitcnt vmcnt(4)
  buffer_load_dwordx4 v[200:203], v4, s[36:39], s88 offen offset:2048 nt
  v_dot2_f32_bf16 v20, v144, v8, 0
  v_dot2_f32_bf16 v21, v148, v8, 0
  v_dot2_f32_bf16 v22, v152, v8, 0
  v_dot2_f32_bf16 v23, v156, v8, 0
  v_dot2c_f32_bf16 v20, v145, v9
  v_dot2c_f32_bf16 v21, v149, v9
  v_dot2c_f32_bf16 v22, v153, v9
  v_dot2c_f32_bf16 v23, v157, v9
  v_dot2c_f32_bf16 v20, v146, v10
  v_dot2c_f32_bf16 v21, v150, v10
  v_dot2c_f32_bf16 v22, v154, v10
  v_dot2c_f32_bf16 v23, v158, v10
  v_dot2c_f32_bf16 v20, v147, v11
  v_dot2c_f32_bf16 v21, v151, v11
  v_dot2c_f32_bf16 v22, v155, v11
  v_dot2c_f32_bf16 v23, v159, v11
  v_add_f32_dpp v24, v20, v20 row_ror:8 row_mask:0xf bank_mask:0x3
  s_nop 1
  v_add_f32_dpp v24, v21, v21 row_ror:8 row_mask:0xf bank_mask:0xc
  v_add_f32_dpp v25, v22, v22 row_ror:8 row_mask:0xf bank_mask:0x3
  s_nop 1
  v_add_f32_dpp v25, v23, v23 row_ror:8 row_mask:0xf bank_mask:0xc
  v_add_f32_dpp v26, v24, v24 row_half_mirror row_mask:0xf bank_mask:0x5
  s_nop 1
  v_add_f32_dpp v26, v25, v25 row_half_mirror row_mask:0xf bank_mask:0xa
  s_nop 1
  v_add_f32_dpp v26, v26, v26 quad_perm:[1,0,3,2] row_mask:0xf bank_mask:0xf
  s_nop 1
  v_add_f32_dpp v26, v26, v26 quad_perm:[2,3,0,1] row_mask:0xf bank_mask:0xf
  v_cndmask_b32 v18, v18, v26, s[54:55]
  s_waitcnt vmcnt(4)
  buffer_load_dwordx4 v[204:207], v4, s[36:39], s88 offen offset:3072 nt
  v_dot2_f32_bf16 v20, v160, v8, 0
  v_dot2_f32_bf16 v21, v164, v8, 0
  v_dot2_f32_bf16 v22, v168, v8, 0
  v_dot2_f32_bf16 v23, v172, v8, 0
  v_dot2c_f32_bf16 v20, v161, v9
  v_dot2c_f32_bf16 v21, v165, v9
  v_dot2c_f32_bf16 v22, v169, v9
  v_dot2c_f32_bf16 v23, v173, v9
  v_dot2c_f32_bf16 v20, v162, v10
  v_dot2c_f32_bf16 v21, v166, v10
  v_dot2c_f32_bf16 v22, v170, v10
  v_dot2c_f32_bf16 v23, v174, v10
  v_dot2c_f32_bf16 v20, v163, v11
  v_dot2c_f32_bf16 v21, v167, v11
  v_dot2c_f32_bf16 v22, v171, v11
  v_dot2c_f32_bf16 v23, v175, v11
  v_add_f32_dpp v24, v20, v20 row_ror:8 row_mask:0xf bank_mask:0x3
  s_nop 1
  v_add_f32_dpp v24, v21, v21 row_ror:8 row_mask:0xf bank_mask:0xc
  v_add_f32_dpp v25, v22, v22 row_ror:8 row_mask:0xf bank_mask:0x3
  s_nop 1
  v_add_f32_dpp v25, v23, v23 row_ror:8 row_mask:0xf bank_mask:0xc
  v_add_f32_dpp v26, v24, v24 row_half_mirror row_mask:0xf bank_mask:0x5
  s_nop 1
  v_add_f32_dpp v26, v25, v25 row_half_mirror row_mask:0xf bank_mask:0xa
  s_nop 1
  v_add_f32_dpp v26, v26, v26 quad_perm:[1,0,3,2] row_mask:0xf bank_mask:0xf
  s_nop 1
  v_add_f32_dpp v19, v26, v26 quad_perm:[2,3,0,1] row_mask:0xf bank_mask:0xf
  s_waitcnt vmcnt(4)
  s_mov_b32 s88, 966656
  buffer_load_dwordx4 v[208:211], v4, s[36:39], s88 offen offset:0 nt
  s_waitcnt vmcnt(4)
  buffer_load_dwordx4 v[212:215], v4, s[36:39], s88 offen offset:1024 nt
  s_waitcnt vmcnt(4)
  buffer_load_dwordx4 v[216:219], v4, s[36:39], s88 offen offset:2048 nt
  s_waitcnt vmcnt(4)
  buffer_load_dwordx4 v[220:223], v4, s[36:39], s88 offen offset:3072 nt
  v_dot2_f32_bf16 v20, v176, v8, 0
  v_dot2_f32_bf16 v21, v180, v8, 0
  v_dot2_f32_bf16 v22, v184, v8, 0
  v_dot2_f32_bf16 v23, v188, v8, 0
  v_dot2c_f32_bf16 v20, v177, v9
  v_dot2c_f32_bf16 v21, v181, v9
  v_dot2c_f32_bf16 v22, v185, v9
  v_dot2c_f32_bf16 v23, v189, v9
  v_dot2c_f32_bf16 v20, v178, v10
  v_dot2c_f32_bf16 v21, v182, v10
  v_dot2c_f32_bf16 v22, v186, v10
  v_dot2c_f32_bf16 v23, v190, v10
  v_dot2c_f32_bf16 v20, v179, v11
  v_dot2c_f32_bf16 v21, v183, v11
  v_dot2c_f32_bf16 v22, v187, v11
  v_dot2c_f32_bf16 v23, v191, v11
  v_add_f32_dpp v24, v20, v20 row_ror:8 row_mask:0xf bank_mask:0x3
  s_nop 1
  v_add_f32_dpp v24, v21, v21 row_ror:8 row_mask:0xf bank_mask:0xc
  v_add_f32_dpp v25, v22, v22 row_ror:8 row_mask:0xf bank_mask:0x3
  s_nop 1
  v_add_f32_dpp v25, v23, v23 row_ror:8 row_mask:0xf bank_mask:0xc
  v_add_f32_dpp v26, v24, v24 row_half_mirror row_mask:0xf bank_mask:0x5
  s_nop 1
  v_add_f32_dpp v26, v25, v25 row_half_mirror row_mask:0xf bank_mask:0xa
  s_nop 1
  v_add_f32_dpp v26, v26, v26 quad_perm:[1,0,3,2] row_mask:0xf bank_mask:0xf
  s_nop 1
  v_add_f32_dpp v26, v26, v26 quad_perm:[2,3,0,1] row_mask:0xf bank_mask:0xf
  v_cndmask_b32 v19, v19, v26, s[50:51]
  s_waitcnt vmcnt(4)
  s_mov_b32 s88, 0
  buffer_load_dwordx4 v[224:227], v4, s[40:43], s88 offen offset:0 nt
  s_waitcnt vmcnt(4)
  buffer_load_dwordx4 v[228:231], v4, s[40:43], s88 offen offset:1024 nt
  s_waitcnt vmcnt(4)
  buffer_load_dwordx4 v[232:235], v4, s[40:43], s88 offen offset:2048 nt
  s_waitcnt vmcnt(4)
  buffer_load_dwordx4 v[236:239], v4, s[40:43], s88 offen offset:3072 nt
  v_dot2_f32_bf16 v20, v192, v8, 0
  v_dot2_f32_bf16 v21, v196, v8, 0
  v_dot2_f32_bf16 v22, v200, v8, 0
  v_dot2_f32_bf16 v23, v204, v8, 0
  v_dot2c_f32_bf16 v20, v193, v9
  v_dot2c_f32_bf16 v21, v197, v9
  v_dot2c_f32_bf16 v22, v201, v9
  v_dot2c_f32_bf16 v23, v205, v9
  v_dot2c_f32_bf16 v20, v194, v10
  v_dot2c_f32_bf16 v21, v198, v10
  v_dot2c_f32_bf16 v22, v202, v10
  v_dot2c_f32_bf16 v23, v206, v10
  v_dot2c_f32_bf16 v20, v195, v11
  v_dot2c_f32_bf16 v21, v199, v11
  v_dot2c_f32_bf16 v22, v203, v11
  v_dot2c_f32_bf16 v23, v207, v11
  v_add_f32_dpp v24, v20, v20 row_ror:8 row_mask:0xf bank_mask:0x3
  s_nop 1
  v_add_f32_dpp v24, v21, v21 row_ror:8 row_mask:0xf bank_mask:0xc
  v_add_f32_dpp v25, v22, v22 row_ror:8 row_mask:0xf bank_mask:0x3
  s_nop 1
  v_add_f32_dpp v25, v23, v23 row_ror:8 row_mask:0xf bank_mask:0xc
  v_add_f32_dpp v26, v24, v24 row_half_mirror row_mask:0xf bank_mask:0x5
  s_nop 1
  v_add_f32_dpp v26, v25, v25 row_half_mirror row_mask:0xf bank_mask:0xa
  s_nop 1
  v_add_f32_dpp v26, v26, v26 quad_perm:[1,0,3,2] row_mask:0xf bank_mask:0xf
  s_nop 1
  v_add_f32_dpp v26, v26, v26 quad_perm:[2,3,0,1] row_mask:0xf bank_mask:0xf
  v_cndmask_b32 v19, v19, v26, s[52:53]
  s_waitcnt vmcnt(4)
  s_mov_b32 s88, 16384
  buffer_load_dwordx4 v[240:243], v4, s[40:43], s88 offen offset:0 nt
  s_waitcnt vmcnt(4)
  buffer_load_dwordx4 v[244:247], v4, s[40:43], s88 offen offset:1024 nt
  s_waitcnt vmcnt(4)
  buffer_load_dwordx4 v[248:251], v4, s[40:43], s88 offen offset:2048 nt
  s_waitcnt vmcnt(4)
  buffer_load_dwordx4 v[252:255], v4, s[40:43], s88 offen offset:3072 nt
  v_dot2_f32_bf16 v20, v208, v8, 0
  v_dot2_f32_bf16 v21, v212, v8, 0
  v_dot2_f32_bf16 v22, v216, v8, 0
  v_dot2_f32_bf16 v23, v220, v8, 0
  v_dot2c_f32_bf16 v20, v209, v9
  v_dot2c_f32_bf16 v21, v213, v9
  v_dot2c_f32_bf16 v22, v217, v9
  v_dot2c_f32_bf16 v23, v221, v9
  v_dot2c_f32_bf16 v20, v210, v10
  v_dot2c_f32_bf16 v21, v214, v10
  v_dot2c_f32_bf16 v22, v218, v10
  v_dot2c_f32_bf16 v23, v222, v10
  v_dot2c_f32_bf16 v20, v211, v11
  v_dot2c_f32_bf16 v21, v215, v11
  v_dot2c_f32_bf16 v22, v219, v11
  v_dot2c_f32_bf16 v23, v223, v11
  v_add_f32_dpp v24, v20, v20 row_ror:8 row_mask:0xf bank_mask:0x3
  s_nop 1
  v_add_f32_dpp v24, v21, v21 row_ror:8 row_mask:0xf bank_mask:0xc
  v_add_f32_dpp v25, v22, v22 row_ror:8 row_mask:0xf bank_mask:0x3
  s_nop 1
  v_add_f32_dpp v25, v23, v23 row_ror:8 row_mask:0xf bank_mask:0xc
  v_add_f32_dpp v26, v24, v24 row_half_mirror row_mask:0xf bank_mask:0x5
  s_nop 1
  v_add_f32_dpp v26, v25, v25 row_half_mirror row_mask:0xf bank_mask:0xa
  s_nop 1
  v_add_f32_dpp v26, v26, v26 quad_perm:[1,0,3,2] row_mask:0xf bank_mask:0xf
  s_nop 1
  v_add_f32_dpp v26, v26, v26 quad_perm:[2,3,0,1] row_mask:0xf bank_mask:0xf
  v_cndmask_b32 v19, v19, v26, s[54:55]
  v_cvt_pk_bf16_f32 v12, 0, v12
  v_cvt_pk_bf16_f32 v13, 0, v13
  v_cvt_pk_bf16_f32 v14, 0, v14
  v_cvt_pk_bf16_f32 v15, 0, v15
  v_cvt_pk_bf16_f32 v16, 0, v16
  v_cvt_pk_bf16_f32 v17, 0, v17
  v_cvt_pk_bf16_f32 v18, 0, v18
  v_cvt_pk_bf16_f32 v19, 0, v19
  v_mul_f32 v12, 0x3db504f3, v12
  v_mul_f32 v13, 0x3db504f3, v13
  v_mul_f32 v14, 0x3db504f3, v14
  v_mul_f32 v15, 0x3db504f3, v15
  v_mul_f32 v16, 0x3db504f3, v16
  v_mul_f32 v17, 0x3db504f3, v17
  v_mul_f32 v18, 0x3db504f3, v18
  v_mul_f32 v19, 0x3db504f3, v19
  v_cvt_pk_bf16_f32 v12, 0, v12
  v_cvt_pk_bf16_f32 v13, 0, v13
  v_cvt_pk_bf16_f32 v14, 0, v14
  v_cvt_pk_bf16_f32 v15, 0, v15
  v_cvt_pk_bf16_f32 v16, 0, v16
  v_cvt_pk_bf16_f32 v17, 0, v17
  v_cvt_pk_bf16_f32 v18, 0, v18
  v_cvt_pk_bf16_f32 v19, 0, v19
  v_max3_f32 v20, v12, v13, v14
  v_max3_f32 v21, v15, v16, v17
  v_max3_f32 v20, v20, v18, v19
  v_max_f32 v20, v20, v21
  s_nop 1
  v_max_f32_dpp v20, v20, v20 row_ror:8 row_mask:0xf bank_mask:0xf
  s_nop 1
  v_max_f32_dpp v20, v20, v20 row_ror:4 row_mask:0xf bank_mask:0xf
  s_nop 1
  v_max_f32_dpp v20, v20, v20 row_ror:2 row_mask:0xf bank_mask:0xf
  s_nop 1
  v_max_f32_dpp v20, v20, v20 row_ror:1 row_mask:0xf bank_mask:0xf
  v_mov_b32 v21, v20
  s_nop 1
  v_permlane16_swap_b32 v20, v21
  v_max_f32 v20, v20, v21
  v_mov_b32 v21, v20
  s_nop 1
  v_permlane32_swap_b32 v20, v21
  v_max_f32 v20, v20, v21
  s_mov_b32 s89, 0x3fb8aa3b
  v_mul_f32 v20, s89, v20
  v_fma_f32 v12, v12, s89, -v20
  v_fma_f32 v13, v13, s89, -v20
  v_fma_f32 v14, v14, s89, -v20
  v_fma_f32 v15, v15, s89, -v20
  v_fma_f32 v16, v16, s89, -v20
  v_fma_f32 v17, v17, s89, -v20
  v_fma_f32 v18, v18, s89, -v20
  v_fma_f32 v19, v19, s89, -v20
  v_exp_f32 v12, v12
  v_exp_f32 v13, v13
  v_exp_f32 v14, v14
  v_exp_f32 v15, v15
  v_exp_f32 v16, v16
  v_exp_f32 v17, v17
  v_exp_f32 v18, v18
  v_exp_f32 v19, v19
  v_cvt_pk_bf16_f32 v12, v12, v12
  v_cvt_pk_bf16_f32 v13, v13, v13
  v_cvt_pk_bf16_f32 v14, v14, v14
  v_cvt_pk_bf16_f32 v15, v15, v15
  v_cvt_pk_bf16_f32 v16, v16, v16
  v_cvt_pk_bf16_f32 v17, v17, v17
  v_cvt_pk_bf16_f32 v18, v18, v18
  v_cvt_pk_bf16_f32 v19, v19, v19
  v_and_b32 v22, 0xffff0000, v12
  v_and_b32 v23, 0xffff0000, v13
  v_and_b32 v24, 0xffff0000, v14
  v_and_b32 v25, 0xffff0000, v15
  v_and_b32 v26, 0xffff0000, v16
  v_and_b32 v27, 0xffff0000, v17
  v_and_b32 v28, 0xffff0000, v18
  v_and_b32 v29, 0xffff0000, v19
  v_add_f32 v21, v22, v23
  v_add_f32 v24, v24, v25
  v_add_f32 v26, v26, v27
  v_add_f32 v28, v28, v29
  v_add_f32 v21, v21, v24
  v_add_f32 v26, v26, v28
  v_add_f32 v21, v21, v26
  s_nop 1
  v_add_f32_dpp v21, v21, v21 row_ror:8 row_mask:0xf bank_mask:0xf
  s_nop 1
  v_add_f32_dpp v21, v21, v21 row_ror:4 row_mask:0xf bank_mask:0xf
  s_nop 1
  v_add_f32_dpp v21, v21, v21 row_ror:2 row_mask:0xf bank_mask:0xf
  s_nop 1
  v_add_f32_dpp v21, v21, v21 row_ror:1 row_mask:0xf bank_mask:0xf
  v_mov_b32 v22, v21
  s_nop 1
  v_permlane16_swap_b32 v21, v22
  v_add_f32 v21, v21, v22
  v_mov_b32 v22, v21
  s_nop 1
  v_permlane32_swap_b32 v21, v22
  v_add_f32 v21, v21, v22
  s_lshl_b32 s89, s3, 3
  v_mov_b32 v22, s89
  ds_write_b64 v22, v[20:21] offset:64
  s_waitcnt lgkmcnt(0)
  s_mov_b64 exec, 1
  v_mov_b32 v22, 1
  v_mov_b32 v23, 0
  ds_add_u32 v23, v22 offset:4
  s_mov_b64 exec, -1
  s_waitcnt vmcnt(4)
  s_mov_b32 s88, 32768
  buffer_load_dwordx4 v[48:51], v4, s[40:43], s88 offen offset:0 nt
  v_and_b32_dpp v20, v12, v36 row_newbcast:0 row_mask:0xf bank_mask:0xf
  v_and_b32_dpp v21, v12, v37 row_newbcast:0 row_mask:0xf bank_mask:0xf
  v_and_b32_dpp v22, v12, v38 row_newbcast:0 row_mask:0xf bank_mask:0xf
  v_and_b32_dpp v23, v12, v39 row_newbcast:0 row_mask:0xf bank_mask:0xf
  s_nop 1
  v_mfma_f32_16x16x32_bf16 v[32:35], v[20:23], v[224:227], 0
  v_and_b32_dpp v28, v12, v36 row_newbcast:8 row_mask:0xf bank_mask:0xf
  v_and_b32_dpp v29, v12, v37 row_newbcast:8 row_mask:0xf bank_mask:0xf
  v_and_b32_dpp v30, v12, v38 row_newbcast:8 row_mask:0xf bank_mask:0xf
  v_and_b32_dpp v31, v12, v39 row_newbcast:8 row_mask:0xf bank_mask:0xf
  s_waitcnt vmcnt(4)
  buffer_load_dwordx4 v[52:55], v4, s[40:43], s88 offen offset:1024 nt
  v_mfma_f32_16x16x32_bf16 v[32:35], v[28:31], v[228:231], v[32:35]
  v_and_b32_dpp v20, v12, v36 row_newbcast:4 row_mask:0xf bank_mask:0xf
  v_and_b32_dpp v21, v12, v37 row_newbcast:4 row_mask:0xf bank_mask:0xf
  v_and_b32_dpp v22, v12, v38 row_newbcast:4 row_mask:0xf bank_mask:0xf
  v_and_b32_dpp v23, v12, v39 row_newbcast:4 row_mask:0xf bank_mask:0xf
  s_waitcnt vmcnt(4)
  buffer_load_dwordx4 v[56:59], v4, s[40:43], s88 offen offset:2048 nt
  v_mfma_f32_16x16x32_bf16 v[32:35], v[20:23], v[232:235], v[32:35]
  v_and_b32_dpp v28, v12, v36 row_newbcast:12 row_mask:0xf bank_mask:0xf
  v_and_b32_dpp v29, v12, v37 row_newbcast:12 row_mask:0xf bank_mask:0xf
  v_and_b32_dpp v30, v12, v38 row_newbcast:12 row_mask:0xf bank_mask:0xf
  v_and_b32_dpp v31, v12, v39 row_newbcast:12 row_mask:0xf bank_mask:0xf
  s_waitcnt vmcnt(4)
  buffer_load_dwordx4 v[60:63], v4, s[40:43], s88 offen offset:3072 nt
  v_mfma_f32_16x16x32_bf16 v[32:35], v[28:31], v[236:239], v[32:35]
  v_and_b32_dpp v20, v12, v36 row_newbcast:1 row_mask:0xf bank_mask:0xf
  v_and_b32_dpp v21, v12, v37 row_newbcast:1 row_mask:0xf bank_mask:0xf
  v_and_b32_dpp v22, v12, v38 row_newbcast:1 row_mask:0xf bank_mask:0xf
  v_and_b32_dpp v23, v12, v39 row_newbcast:1 row_mask:0xf bank_mask:0xf
  s_waitcnt vmcnt(4)
  s_mov_b32 s88, 49152
  buffer_load_dwordx4 v[64:67], v4, s[40:43], s88 offen offset:0 nt
  v_mfma_f32_16x16x32_bf16 v[32:35], v[20:23], v[240:243], v[32:35]
  v_and_b32_dpp v28, v12, v36 row_newbcast:9 row_mask:0xf bank_mask:0xf
  v_and_b32_dpp v29, v12, v37 row_newbcast:9 row_mask:0xf bank_mask:0xf
  v_and_b32_dpp v30, v12, v38 row_newbcast:9 row_mask:0xf bank_mask:0xf
  v_and_b32_dpp v31, v12, v39 row_newbcast:9 row_mask:0xf bank_mask:0xf
  s_waitcnt vmcnt(4)
  buffer_load_dwordx4 v[68:71], v4, s[40:43], s88 offen offset:1024 nt
  v_mfma_f32_16x16x32_bf16 v[32:35], v[28:31], v[244:247], v[32:35]
  v_and_b32_dpp v20, v12, v36 row_newbcast:5 row_mask:0xf bank_mask:0xf
  v_and_b32_dpp v21, v12, v37 row_newbcast:5 row_mask:0xf bank_mask:0xf
  v_and_b32_dpp v22, v12, v38 row_newbcast:5 row_mask:0xf bank_mask:0xf
  v_and_b32_dpp v23, v12, v39 row_newbcast:5 row_mask:0xf bank_mask:0xf
  s_waitcnt vmcnt(4)
  buffer_load_dwordx4 v[72:75], v4, s[40:43], s88 offen offset:2048 nt
  v_mfma_f32_16x16x32_bf16 v[32:35], v[20:23], v[248:251], v[32:35]
  v_and_b32_dpp v28, v12, v36 row_newbcast:13 row_mask:0xf bank_mask:0xf
  v_and_b32_dpp v29, v12, v37 row_newbcast:13 row_mask:0xf bank_mask:0xf
  v_and_b32_dpp v30, v12, v38 row_newbcast:13 row_mask:0xf bank_mask:0xf
  v_and_b32_dpp v31, v12, v39 row_newbcast:13 row_mask:0xf bank_mask:0xf
  s_waitcnt vmcnt(4)
  buffer_load_dwordx4 v[76:79], v4, s[40:43], s88 offen offset:3072 nt
  v_mfma_f32_16x16x32_bf16 v[32:35], v[28:31], v[252:255], v[32:35]
  v_and_b32_dpp v20, v12, v36 row_newbcast:2 row_mask:0xf bank_mask:0xf
  v_and_b32_dpp v21, v12, v37 row_newbcast:2 row_mask:0xf bank_mask:0xf
  v_and_b32_dpp v22, v12, v38 row_newbcast:2 row_mask:0xf bank_mask:0xf
  v_and_b32_dpp v23, v12, v39 row_newbcast:2 row_mask:0xf bank_mask:0xf
  s_sub_u32 s93, s2, 64
  s_and_b32 s93, s93, 0xfffffff0
  s_and_b32 s90, s2, 7
  s_lshl_b32 s90, s90, 1
  s_add_u32 s93, s93, s90
  s_bfe_u32 s90, s2, 0x10003
  s_add_u32 s93, s93, s90
  s_cmp_lt_u32 s93, 56
  s_cselect_b32 s93, 104, 0
  s_cmp_eq_u32 s33, 1
  s_cselect_b32 s93, 72, s93
  s_cmp_eq_u32 s33, 0
  s_cselect_b32 s93, 0, s93
  s_movk_i32 s92, 144
  s_mov_b32 s94, 131072
  s_lshl_b32 s89, s3, 2
  v_mov_b32 v42, s89
  v_mov_b32 v43, 0
L_vloop:
  s_waitcnt lgkmcnt(0)
  v_readfirstlane_b32 s89, v43
  v_mov_b32 v41, s92
  ds_write_b32 v42, v41 offset:12
  ds_read_b32 v43, v40 offset:8
  s_cmp_eq_u32 s89, 0
  s_cselect_b32 s89, s93, s89
  s_add_i32 s89, s89, s92
  s_add_u32 s92, s92, 8
  s_cmpk_ge_i32 s89, 0x100
  s_cselect_b64 vcc, -1, 0
  s_cbranch_vccnz L_w_80
  s_waitcnt vmcnt(4)
L_w_80:
  s_waitcnt vmcnt(7)
  s_add_u32 s88, s94, 0
  buffer_load_dwordx4 v[224:227], v4, s[40:43], s88 offen offset:0 nt
  v_mfma_f32_16x16x32_bf16 v[32:35], v[20:23], v[48:51], v[32:35]
  v_and_b32_dpp v28, v12, v36 row_newbcast:10 row_mask:0xf bank_mask:0xf
  v_and_b32_dpp v29, v12, v37 row_newbcast:10 row_mask:0xf bank_mask:0xf
  v_and_b32_dpp v30, v12, v38 row_newbcast:10 row_mask:0xf bank_mask:0xf
  v_and_b32_dpp v31, v12, v39 row_newbcast:10 row_mask:0xf bank_mask:0xf
  s_cbranch_vccnz L_w_81
  s_waitcnt vmcnt(4)
L_w_81:
  s_waitcnt vmcnt(7)
  buffer_load_dwordx4 v[228:231], v4, s[40:43], s88 offen offset:1024 nt
  v_mfma_f32_16x16x32_bf16 v[32:35], v[28:31], v[52:55], v[32:35]
  v_and_b32_dpp v20, v12, v36 row_newbcast:6 row_mask:0xf bank_mask:0xf
  v_and_b32_dpp v21, v12, v37 row_newbcast:6 row_mask:0xf bank_mask:0xf
  v_and_b32_dpp v22, v12, v38 row_newbcast:6 row_mask:0xf bank_mask:0xf
  v_and_b32_dpp v23, v12, v39 row_newbcast:6 row_mask:0xf bank_mask:0xf
  s_cbranch_vccnz L_w_82
  s_waitcnt vmcnt(4)
L_w_82:
  s_waitcnt vmcnt(7)
  buffer_load_dwordx4 v[232:235], v4, s[40:43], s88 offen offset:2048 nt
  v_mfma_f32_16x16x32_bf16 v[32:35], v[20:23], v[56:59], v[32:35]
  v_and_b32_dpp v28, v12, v36 row_newbcast:14 row_mask:0xf bank_mask:0xf
  v_and_b32_dpp v29, v12, v37 row_newbcast:14 row_mask:0xf bank_mask:0xf
  v_and_b32_dpp v30, v12, v38 row_newbcast:14 row_mask:0xf bank_mask:0xf
  v_and_b32_dpp v31, v12, v39 row_newbcast:14 row_mask:0xf bank_mask:0xf
  s_cbranch_vccnz L_w_83
  s_waitcnt vmcnt(4)
L_w_83:
  s_waitcnt vmcnt(7)
  buffer_load_dwordx4 v[236:239], v4, s[40:43], s88 offen offset:3072 nt
  v_mfma_f32_16x16x32_bf16 v[32:35], v[28:31], v[60:63], v[32:35]
  v_and_b32_dpp v20, v12, v36 row_newbcast:3 row_mask:0xf bank_mask:0xf
  v_and_b32_dpp v21, v12, v37 row_newbcast:3 row_mask:0xf bank_mask:0xf
  v_and_b32_dpp v22, v12, v38 row_newbcast:3 row_mask:0xf bank_mask:0xf
  v_and_b32_dpp v23, v12, v39 row_newbcast:3 row_mask:0xf bank_mask:0xf
  s_cbranch_vccnz L_w_84
  s_waitcnt vmcnt(4)
L_w_84:
  s_waitcnt vmcnt(7)
  s_add_u32 s88, s94, 16384
  buffer_load_dwordx4 v[240:243], v4, s[40:43], s88 offen offset:0 nt
  v_mfma_f32_16x16x32_bf16 v[32:35], v[20:23], v[64:67], v[32:35]
  v_and_b32_dpp v28, v12, v36 row_newbcast:11 row_mask:0xf bank_mask:0xf
  v_and_b32_dpp v29, v12, v37 row_newbcast:11 row_mask:0xf bank_mask:0xf
  v_and_b32_dpp v30, v12, v38 row_newbcast:11 row_mask:0xf bank_mask:0xf
  v_and_b32_dpp v31, v12, v39 row_newbcast:11 row_mask:0xf bank_mask:0xf
  s_cbranch_vccnz L_w_85
  s_waitcnt vmcnt(4)
L_w_85:
  s_waitcnt vmcnt(7)
  buffer_load_dwordx4 v[244:247], v4, s[40:43], s88 offen offset:1024 nt
  v_mfma_f32_16x16x32_bf16 v[32:35], v[28:31], v[68:71], v[32:35]
  v_and_b32_dpp v20, v12, v36 row_newbcast:7 row_mask:0xf bank_mask:0xf
  v_and_b32_dpp v21, v12, v37 row_newbcast:7 row_mask:0xf bank_mask:0xf
  v_and_b32_dpp v22, v12, v38 row_newbcast:7 row_mask:0xf bank_mask:0xf
  v_and_b32_dpp v23, v12, v39 row_newbcast:7 row_mask:0xf bank_mask:0xf
  s_cbranch_vccnz L_w_86
  s_waitcnt vmcnt(4)
L_w_86:
  s_waitcnt vmcnt(7)
  buffer_load_dwordx4 v[248:251], v4, s[40:43], s88 offen offset:2048 nt
  v_mfma_f32_16x16x32_bf16 v[32:35], v[20:23], v[72:75], v[32:35]
  v_and_b32_dpp v28, v12, v36 row_newbcast:15 row_mask:0xf bank_mask:0xf
  v_and_b32_dpp v29, v12, v37 row_newbcast:15 row_mask:0xf bank_mask:0xf
  v_and_b32_dpp v30, v12, v38 row_newbcast:15 row_mask:0xf bank_mask:0xf
  v_and_b32_dpp v31, v12, v39 row_newbcast:15 row_mask:0xf bank_mask:0xf
  s_cbranch_vccnz L_w_87
  s_waitcnt vmcnt(4)
L_w_87:
  s_waitcnt vmcnt(7)
  buffer_load_dwordx4 v[252:255], v4, s[40:43], s88 offen offset:3072 nt
  v_mfma_f32_16x16x32_bf16 v[32:35], v[28:31], v[76:79], v[32:35]
  v_mov_b32 v12, v13
  v_mov_b32 v13, v14
  v_mov_b32 v14, v15
  v_mov_b32 v15, v16
  v_mov_b32 v16, v17
  v_mov_b32 v17, v18
  v_mov_b32 v18, v19
  v_and_b32_dpp v20, v12, v36 row_newbcast:0 row_mask:0xf bank_mask:0xf
  v_and_b32_dpp v21, v12, v37 row_newbcast:0 row_mask:0xf bank_mask:0xf
  v_and_b32_dpp v22, v12, v38 row_newbcast:0 row_mask:0xf bank_mask:0xf
  v_and_b32_dpp v23, v12, v39 row_newbcast:0 row_mask:0xf bank_mask:0xf
  s_waitcnt lgkmcnt(0)
  v_readfirstlane_b32 s89, v43
  v_mov_b32 v41, s92
  ds_write_b32 v42, v41 offset:12
  ds_read_b32 v43, v40 offset:8
  s_cmp_eq_u32 s89, 0
  s_cselect_b32 s89, s93, s89
  s_add_i32 s89, s89, s92
  s_add_u32 s92, s92, 8
  s_cmpk_ge_i32 s89, 0x100
  s_cselect_b64 vcc, -1, 0
  s_cbranch_vccnz L_w_88
  s_waitcnt vmcnt(4)
L_w_88:
  s_waitcnt vmcnt(7)
  s_add_u32 s88, s94, 32768
  buffer_load_dwordx4 v[48:51], v4, s[40:43], s88 offen offset:0 nt
  v_mfma_f32_16x16x32_bf16 v[32:35], v[20:23], v[224:227], v[32:35]
  v_and_b32_dpp v28, v12, v36 row_newbcast:8 row_mask:0xf bank_mask:0xf
  v_and_b32_dpp v29, v12, v37 row_newbcast:8 row_mask:0xf bank_mask:0xf
  v_and_b32_dpp v30, v12, v38 row_newbcast:8 row_mask:0xf bank_mask:0xf
  v_and_b32_dpp v31, v12, v39 row_newbcast:8 row_mask:0xf bank_mask:0xf
  s_cbranch_vccnz L_w_89
  s_waitcnt vmcnt(4)
L_w_89:
  s_waitcnt vmcnt(7)
  buffer_load_dwordx4 v[52:55], v4, s[40:43], s88 offen offset:1024 nt
  v_mfma_f32_16x16x32_bf16 v[32:35], v[28:31], v[228:231], v[32:35]
  v_and_b32_dpp v20, v12, v36 row_newbcast:4 row_mask:0xf bank_mask:0xf
  v_and_b32_dpp v21, v12, v37 row_newbcast:4 row_mask:0xf bank_mask:0xf
  v_and_b32_dpp v22, v12, v38 row_newbcast:4 row_mask:0xf bank_mask:0xf
  v_and_b32_dpp v23, v12, v39 row_newbcast:4 row_mask:0xf bank_mask:0xf
  s_cbranch_vccnz L_w_90
  s_waitcnt vmcnt(4)
L_w_90:
  s_waitcnt vmcnt(7)
  buffer_load_dwordx4 v[56:59], v4, s[40:43], s88 offen offset:2048 nt
  v_mfma_f32_16x16x32_bf16 v[32:35], v[20:23], v[232:235], v[32:35]
  v_and_b32_dpp v28, v12, v36 row_newbcast:12 row_mask:0xf bank_mask:0xf
  v_and_b32_dpp v29, v12, v37 row_newbcast:12 row_mask:0xf bank_mask:0xf
  v_and_b32_dpp v30, v12, v38 row_newbcast:12 row_mask:0xf bank_mask:0xf
  v_and_b32_dpp v31, v12, v39 row_newbcast:12 row_mask:0xf bank_mask:0xf
  s_cbranch_vccnz L_w_91
  s_waitcnt vmcnt(4)
L_w_91:
  s_waitcnt vmcnt(7)
  buffer_load_dwordx4 v[60:63], v4, s[40:43], s88 offen offset:3072 nt
  v_mfma_f32_16x16x32_bf16 v[32:35], v[28:31], v[236:239], v[32:35]
  v_and_b32_dpp v20, v12, v36 row_newbcast:1 row_mask:0xf bank_mask:0xf
  v_and_b32_dpp v21, v12, v37 row_newbcast:1 row_mask:0xf bank_mask:0xf
  v_and_b32_dpp v22, v12, v38 row_newbcast:1 row_mask:0xf bank_mask:0xf
  v_and_b32_dpp v23, v12, v39 row_newbcast:1 row_mask:0xf bank_mask:0xf
  s_cbranch_vccnz L_w_92
  s_waitcnt vmcnt(4)
L_w_92:
  s_waitcnt vmcnt(7)
  s_add_u32 s88, s94, 49152
  buffer_load_dwordx4 v[64:67], v4, s[40:43], s88 offen offset:0 nt
  v_mfma_f32_16x16x32_bf16 v[32:35], v[20:23], v[240:243], v[32:35]
  v_and_b32_dpp v28, v12, v36 row_newbcast:9 row_mask:0xf bank_mask:0xf
  v_and_b32_dpp v29, v12, v37 row_newbcast:9 row_mask:0xf bank_mask:0xf
  v_and_b32_dpp v30, v12, v38 row_newbcast:9 row_mask:0xf bank_mask:0xf
  v_and_b32_dpp v31, v12, v39 row_newbcast:9 row_mask:0xf bank_mask:0xf
  s_cbranch_vccnz L_w_93
  s_waitcnt vmcnt(4)
L_w_93:
  s_waitcnt vmcnt(7)
  buffer_load_dwordx4 v[68:71], v4, s[40:43], s88 offen offset:1024 nt
  v_mfma_f32_16x16x32_bf16 v[32:35], v[28:31], v[244:247], v[32:35]
  v_and_b32_dpp v20, v12, v36 row_newbcast:5 row_mask:0xf bank_mask:0xf
  v_and_b32_dpp v21, v12, v37 row_newbcast:5 row_mask:0xf bank_mask:0xf
  v_and_b32_dpp v22, v12, v38 row_newbcast:5 row_mask:0xf bank_mask:0xf
  v_and_b32_dpp v23, v12, v39 row_newbcast:5 row_mask:0xf bank_mask:0xf
  s_cbranch_vccnz L_w_94
  s_waitcnt vmcnt(4)
L_w_94:
  s_waitcnt vmcnt(7)
  buffer_load_dwordx4 v[72:75], v4, s[40:43], s88 offen offset:2048 nt
  v_mfma_f32_16x16x32_bf16 v[32:35], v[20:23], v[248:251], v[32:35]
  v_and_b32_dpp v28, v12, v36 row_newbcast:13 row_mask:0xf bank_mask:0xf
  v_and_b32_dpp v29, v12, v37 row_newbcast:13 row_mask:0xf bank_mask:0xf
  v_and_b32_dpp v30, v12, v38 row_newbcast:13 row_mask:0xf bank_mask:0xf
  v_and_b32_dpp v31, v12, v39 row_newbcast:13 row_mask:0xf bank_mask:0xf
  s_cbranch_vccnz L_w_95
  s_waitcnt vmcnt(4)
L_w_95:
  s_waitcnt vmcnt(7)
  buffer_load_dwordx4 v[76:79], v4, s[40:43], s88 offen offset:3072 nt
  v_mfma_f32_16x16x32_bf16 v[32:35], v[28:31], v[252:255], v[32:35]
  v_and_b32_dpp v20, v12, v36 row_newbcast:2 row_mask:0xf bank_mask:0xf
  v_and_b32_dpp v21, v12, v37 row_newbcast:2 row_mask:0xf bank_mask:0xf
  v_and_b32_dpp v22, v12, v38 row_newbcast:2 row_mask:0xf bank_mask:0xf
  v_and_b32_dpp v23, v12, v39 row_newbcast:2 row_mask:0xf bank_mask:0xf
  s_add_u32 s94, s94, 131072
  s_and_b32 s94, s94, 1048575
  s_cmpk_lt_u32 s92, 0x100
  s_cbranch_scc1 L_vloop
  s_waitcnt vmcnt(7)
  v_mfma_f32_16x16x32_bf16 v[32:35], v[20:23], v[48:51], v[32:35]
  v_and_b32_dpp v28, v12, v36 row_newbcast:10 row_mask:0xf bank_mask:0xf
  v_and_b32_dpp v29, v12, v37 row_newbcast:10 row_mask:0xf bank_mask:0xf
  v_and_b32_dpp v30, v12, v38 row_newbcast:10 row_mask:0xf bank_mask:0xf
  v_and_b32_dpp v31, v12, v39 row_newbcast:10 row_mask:0xf bank_mask:0xf
  s_waitcnt vmcnt(6)
  s_nop 0
  v_mfma_f32_16x16x32_bf16 v[32:35], v[28:31], v[52:55], v[32:35]
  v_and_b32_dpp v20, v12, v36 row_newbcast:6 row_mask:0xf bank_mask:0xf
  v_and_b32_dpp v21, v12, v37 row_newbcast:6 row_mask:0xf bank_mask:0xf
  v_and_b32_dpp v22, v12, v38 row_newbcast:6 row_mask:0xf bank_mask:0xf
  v_and_b32_dpp v23, v12, v39 row_newbcast:6 row_mask:0xf bank_mask:0xf
  s_waitcnt vmcnt(5)
  s_nop 0
  v_mfma_f32_16x16x32_bf16 v[32:35], v[20:23], v[56:59], v[32:35]
  v_and_b32_dpp v28, v12, v36 row_newbcast:14 row_mask:0xf bank_mask:0xf
  v_and_b32_dpp v29, v12, v37 row_newbcast:14 row_mask:0xf bank_mask:0xf
  v_and_b32_dpp v30, v12, v38 row_newbcast:14 row_mask:0xf bank_mask:0xf
  v_and_b32_dpp v31, v12, v39 row_newbcast:14 row_mask:0xf bank_mask:0xf
  s_waitcnt vmcnt(4)
  s_nop 0
  v_mfma_f32_16x16x32_bf16 v[32:35], v[28:31], v[60:63], v[32:35]
  v_and_b32_dpp v20, v12, v36 row_newbcast:3 row_mask:0xf bank_mask:0xf
  v_and_b32_dpp v21, v12, v37 row_newbcast:3 row_mask:0xf bank_mask:0xf
  v_and_b32_dpp v22, v12, v38 row_newbcast:3 row_mask:0xf bank_mask:0xf
  v_and_b32_dpp v23, v12, v39 row_newbcast:3 row_mask:0xf bank_mask:0xf
  s_waitcnt vmcnt(3)
  s_nop 0
  v_mfma_f32_16x16x32_bf16 v[32:35], v[20:23], v[64:67], v[32:35]
  v_and_b32_dpp v28, v12, v36 row_newbcast:11 row_mask:0xf bank_mask:0xf
  v_and_b32_dpp v29, v12, v37 row_newbcast:11 row_mask:0xf bank_mask:0xf
  v_and_b32_dpp v30, v12, v38 row_newbcast:11 row_mask:0xf bank_mask:0xf
  v_and_b32_dpp v31, v12, v39 row_newbcast:11 row_mask:0xf bank_mask:0xf
  s_waitcnt vmcnt(2)
  s_nop 0
  v_mfma_f32_16x16x32_bf16 v[32:35], v[28:31], v[68:71], v[32:35]
  v_and_b32_dpp v20, v12, v36 row_newbcast:7 row_mask:0xf bank_mask:0xf
  v_and_b32_dpp v21, v12, v37 row_newbcast:7 row_mask:0xf bank_mask:0xf
  v_and_b32_dpp v22, v12, v38 row_newbcast:7 row_mask:0xf bank_mask:0xf
  v_and_b32_dpp v23, v12, v39 row_newbcast:7 row_mask:0xf bank_mask:0xf
  s_waitcnt vmcnt(1)
  s_nop 0
  v_mfma_f32_16x16x32_bf16 v[32:35], v[20:23], v[72:75], v[32:35]
  v_and_b32_dpp v28, v12, v36 row_newbcast:15 row_mask:0xf bank_mask:0xf
  v_and_b32_dpp v29, v12, v37 row_newbcast:15 row_mask:0xf bank_mask:0xf
  v_and_b32_dpp v30, v12, v38 row_newbcast:15 row_mask:0xf bank_mask:0xf
  v_and_b32_dpp v31, v12, v39 row_newbcast:15 row_mask:0xf bank_mask:0xf
  s_waitcnt vmcnt(0)
  s_nop 0
  v_mfma_f32_16x16x32_bf16 v[32:35], v[28:31], v[76:79], v[32:35]
  s_mov_b32 exec_hi, 0
  s_nop 6
  v_cvt_pk_bf16_f32 v20, v32, v33
  v_cvt_pk_bf16_f32 v21, v34, v35
  ds_write_b16 v5, v20 offset:14336
  ds_write_b16_d16_hi v5, v20 offset:14352
  ds_write_b16 v5, v21 offset:14368
  ds_write_b16_d16_hi v5, v21 offset:14384
  s_waitcnt lgkmcnt(0)
  s_barrier
  s_endpgm
L_H0:
  v_mov_b32 v4, 0
  v_mov_b32 v5, 0
  ds_write_b64 v4, v[4:5]
  ds_write_b64 v4, v[4:5] offset:8
  v_and_b32 v2, 15, v0
  v_lshrrev_b32 v3, 4, v1
  s_and_b32 s34, s2, 63
  s_mov_b32 s46, 1900544
  s_mov_b32 s47, 0x20000
  s_waitcnt lgkmcnt(0)
  s_mov_b32 s72, s22
  s_mov_b32 s73, s23
  s_mov_b32 s74, 3145728
  s_mov_b32 s75, 0x20000
  s_mov_b32 s44, s28
  s_mov_b32 s45, s29
  s_barrier
L_H:
  s_load_dwordx2 s[98:99], s[28:29], 0
  s_and_b32 s35, s3, 3
  s_mov_b32 s48, s4
  s_mov_b32 s49, s5
  s_mov_b32 s50, 4096
  s_mov_b32 s51, 0x20000
  s_mov_b32 s52, s10
  s_mov_b32 s53, s11
  s_mov_b32 s54, 4194304
  s_mov_b32 s55, 0x20000
  s_mov_b32 s56, s12
  s_mov_b32 s57, s13
  s_mov_b32 s58, 4194304
  s_mov_b32 s59, 0x20000
  s_mov_b32 s60, s16
  s_mov_b32 s61, s17
  s_mov_b32 s62, 1835008
  s_mov_b32 s63, 0x20000
  s_mov_b32 s64, s18
  s_mov_b32 s65, s19
  s_mov_b32 s66, 1835008
  s_mov_b32 s67, 0x20000
  s_mov_b32 s68, s20
  s_mov_b32 s69, s21
  s_mov_b32 s70, 4096
  s_mov_b32 s71, 0x20000
  s_mov_b32 s76, s24
  s_mov_b32 s77, s25
  s_mov_b32 s78, 4096
  s_mov_b32 s79, 0x20000
  s_mov_b32 s86, 0x05040100
  s_mov_b32 s87, 0x07060302
  v_lshrrev_b32 v6, 2, v2
  s_sub_u32 s36, s2, 64
  s_and_b32 s36, s36, 0xfffffff0
  s_and_b32 s88, s2, 7
  s_lshl_b32 s88, s88, 1
  s_add_u32 s36, s36, s88
  s_bfe_u32 s88, s2, 0x10003
  s_add_u32 s36, s36, s88
  s_sub_u32 s40, s2, 128
  s_cmp_ge_u32 s3, 4
  s_cbranch_scc1 L_Q1
  s_and_b32 s37, s2, 7
  s_lshr_b32 s38, s2, 3
  s_lshl_b32 s88, s38, 2
  s_add_u32 s88, s88, s35
  s_mul_i32 s94, s88, 196608
  s_lshl_b32 s39, s37, 7
  s_add_u32 s94, s94, s39
  s_lshl_b32 s88, s88, 6
  v_mul_u32_u24 v9, 49152, v3
  v_and_b32 v10, 7, v1
  v_lshl_add_u32 v9, v10, 4, v9
  v_lshrrev_b32 v10, 3, v2
  v_lshl_add_u32 v9, v10, 10, v9
  v_lshlrev_b32 v8, 10, v6
  v_lshl_add_u32 v8, v3, 4, v8
  buffer_load_dwordx4 v[20:23], v8, s[68:71], s88 offen
  s_add_u32 s89, s94, 0
  buffer_load_dwordx4 v[192:195], v9, s[72:75], s89 offen nt
  s_add_u32 s89, s94, 6144
  buffer_load_dwordx4 v[196:199], v9, s[72:75], s89 offen nt
  s_add_u32 s89, s94, 12288
  buffer_load_dwordx4 v[200:203], v9, s[72:75], s89 offen nt
  s_add_u32 s89, s94, 18432
  buffer_load_dwordx4 v[204:207], v9, s[72:75], s89 offen nt
  s_add_u32 s89, s94, 24576
  buffer_load_dwordx4 v[208:211], v9, s[72:75], s89 offen nt
  s_add_u32 s89, s94, 30720
  buffer_load_dwordx4 v[212:215], v9, s[72:75], s89 offen nt
  s_add_u32 s89, s94, 36864
  buffer_load_dwordx4 v[216:219], v9, s[72:75], s89 offen nt
  s_add_u32 s89, s94, 43008
  buffer_load_dwordx4 v[220:223], v9, s[72:75], s89 offen nt
  s_cmp_lg_u32 s35, 0
  s_cbranch_scc1 L_nox
  v_lshlrev_b32 v8, 10, v3
  v_lshl_add_u32 v12, v2, 6, v8
  v_lshl_add_u32 v8, v2, 3, v8
  buffer_load_dwordx4 v[64:67], v12, s[48:51], 0 offen offset:0
  buffer_load_dwordx4 v[68:71], v12, s[48:51], 0 offen offset:16
  buffer_load_dwordx4 v[72:75], v12, s[48:51], 0 offen offset:32
  buffer_load_dwordx4 v[76:79], v12, s[48:51], 0 offen offset:48
  buffer_load_dwordx2 v[80:81], v8, s[48:51], s39 offen
  s_waitcnt vmcnt(13)
  s_branch L_nox2
L_nox:
  s_waitcnt vmcnt(8)
L_nox2:
  v_lshlrev_b32 v32, 16, v20
  v_and_b32 v33, 0xffff0000, v20
  v_lshlrev_b32 v34, 16, v21
  v_and_b32 v35, 0xffff0000, v21
  v_lshlrev_b32 v36, 16, v22
  v_and_b32 v37, 0xffff0000, v22
  v_lshlrev_b32 v38, 16, v23
  v_and_b32 v39, 0xffff0000, v23
  v_mul_f32 v40, 0xbfb8aa3b, v32
  v_mul_f32 v41, 0xbfb8aa3b, v33
  v_mul_f32 v42, 0xbfb8aa3b, v34
  v_mul_f32 v43, 0xbfb8aa3b, v35
  v_mul_f32 v44, 0xbfb8aa3b, v36
  v_mul_f32 v45, 0xbfb8aa3b, v37
  v_mul_f32 v46, 0xbfb8aa3b, v38
  v_mul_f32 v47, 0xbfb8aa3b, v39
  v_exp_f32 v40, v40
  v_exp_f32 v41, v41
  v_exp_f32 v42, v42
  v_exp_f32 v43, v43
  v_exp_f32 v44, v44
  v_exp_f32 v45, v45
  v_exp_f32 v46, v46
  v_exp_f32 v47, v47
  v_add_f32 v40, 1.0, v40
  v_add_f32 v41, 1.0, v41
  v_add_f32 v42, 1.0, v42
  v_add_f32 v43, 1.0, v43
  v_add_f32 v44, 1.0, v44
  v_add_f32 v45, 1.0, v45
  v_add_f32 v46, 1.0, v46
  v_add_f32 v47, 1.0, v47
  v_rcp_f32 v40, v40
  v_rcp_f32 v41, v41
  v_rcp_f32 v42, v42
  v_rcp_f32 v43, v43
  v_rcp_f32 v44, v44
  v_rcp_f32 v45, v45
  v_rcp_f32 v46, v46
  v_rcp_f32 v47, v47
  v_mul_f32 v32, v32, v40
  v_mul_f32 v33, v33, v41
  v_mul_f32 v34, v34, v42
  v_mul_f32 v35, v35, v43
  v_mul_f32 v36, v36, v44
  v_mul_f32 v37, v37, v45
  v_mul_f32 v38, v38, v46
  v_mul_f32 v39, v39, v47
  v_cvt_pk_bf16_f32 v20, v32, v33
  v_cvt_pk_bf16_f32 v21, v34, v35
  v_cvt_pk_bf16_f32 v22, v36, v37
  v_cvt_pk_bf16_f32 v23, v38, v39
  s_lshl_b32 s88, s35, 11
  v_add_u32 v8, s88, v7
  s_waitcnt vmcnt(0)
  v_perm_b32 v224, v196, v192, s86
  v_perm_b32 v225, v204, v200, s86
  v_perm_b32 v226, v212, v208, s86
  v_perm_b32 v227, v220, v216, s86
  v_perm_b32 v228, v196, v192, s87
  v_perm_b32 v229, v204, v200, s87
  v_perm_b32 v230, v212, v208, s87
  v_perm_b32 v231, v220, v216, s87
  v_perm_b32 v232, v197, v193, s86
  v_perm_b32 v233, v205, v201, s86
  v_perm_b32 v234, v213, v209, s86
  v_perm_b32 v235, v221, v217, s86
  v_perm_b32 v236, v197, v193, s87
  v_perm_b32 v237, v205, v201, s87
  v_perm_b32 v238, v213, v209, s87
  v_perm_b32 v239, v221, v217, s87
  v_perm_b32 v240, v198, v194, s86
  v_perm_b32 v241, v206, v202, s86
  v_perm_b32 v242, v214, v210, s86
  v_perm_b32 v243, v222, v218, s86
  v_perm_b32 v244, v198, v194, s87
  v_perm_b32 v245, v206, v202, s87
  v_perm_b32 v246, v214, v210, s87
  v_perm_b32 v247, v222, v218, s87
  v_perm_b32 v248, v199, v195, s86
  v_perm_b32 v249, v207, v203, s86
  v_perm_b32 v250, v215, v211, s86
  v_perm_b32 v251, v223, v219, s86
  v_perm_b32 v252, v199, v195, s87
  v_perm_b32 v253, v207, v203, s87
  v_perm_b32 v254, v215, v211, s87
  v_perm_b32 v255, v223, v219, s87
  v_mfma_f32_16x16x32_bf16 v[32:35], v[20:23], v[224:227], 0
  v_mfma_f32_16x16x32_bf16 v[36:39], v[20:23], v[228:231], 0
  v_mfma_f32_16x16x32_bf16 v[40:43], v[20:23], v[232:235], 0
  v_mfma_f32_16x16x32_bf16 v[44:47], v[20:23], v[236:239], 0
  v_mfma_f32_16x16x32_bf16 v[48:51], v[20:23], v[240:243], 0
  v_mfma_f32_16x16x32_bf16 v[52:55], v[20:23], v[244:247], 0
  v_mfma_f32_16x16x32_bf16 v[56:59], v[20:23], v[248:251], 0
  v_mfma_f32_16x16x32_bf16 v[60:63], v[20:23], v[252:255], 0
  s_nop 0
  v_mov_b32 v12, v32
  v_mov_b32 v13, v36
  v_mov_b32 v14, v40
  v_mov_b32 v15, v44
  v_mov_b32 v16, v48
  v_mov_b32 v17, v52
  v_mov_b32 v18, v56
  v_mov_b32 v19, v60
  ds_write_b128 v8, v[12:15] offset:2048
  ds_write_b128 v8, v[16:19] offset:3072
  s_waitcnt lgkmcnt(0)
  s_mov_b64 exec, 1
  v_mov_b32 v24, 1
  v_mov_b32 v25, 0
  ds_add_u32 v25, v24 offset:0
  s_mov_b64 exec, -1
  s_cmp_lg_u32 s35, 0
  s_cbranch_scc1 L_Mret
  v_lshlrev_b32 v96, 16, v64
  v_and_b32 v97, 0xffff0000, v64
  v_lshlrev_b32 v98, 16, v65
  v_and_b32 v99, 0xffff0000, v65
  v_lshlrev_b32 v100, 16, v66
  v_and_b32 v101, 0xffff0000, v66
  v_lshlrev_b32 v102, 16, v67
  v_and_b32 v103, 0xffff0000, v67
  v_lshlrev_b32 v104, 16, v68
  v_and_b32 v105, 0xffff0000, v68
  v_lshlrev_b32 v106, 16, v69
  v_and_b32 v107, 0xffff0000, v69
  v_lshlrev_b32 v108, 16, v70
  v_and_b32 v109, 0xffff0000, v70
  v_lshlrev_b32 v110, 16, v71
  v_and_b32 v111, 0xffff0000, v71
  v_lshlrev_b32 v112, 16, v72
  v_and_b32 v113, 0xffff0000, v72
  v_lshlrev_b32 v114, 16, v73
  v_and_b32 v115, 0xffff0000, v73
  v_lshlrev_b32 v116, 16, v74
  v_and_b32 v117, 0xffff0000, v74
  v_lshlrev_b32 v118, 16, v75
  v_and_b32 v119, 0xffff0000, v75
  v_lshlrev_b32 v120, 16, v76
  v_and_b32 v121, 0xffff0000, v76
  v_lshlrev_b32 v122, 16, v77
  v_and_b32 v123, 0xffff0000, v77
  v_lshlrev_b32 v124, 16, v78
  v_and_b32 v125, 0xffff0000, v78
  v_lshlrev_b32 v126, 16, v79
  v_and_b32 v127, 0xffff0000, v79
  v_pk_add_f32 v[128:129], v[96:97], v[98:99]
  v_pk_add_f32 v[130:131], v[100:101], v[102:103]
  v_pk_add_f32 v[132:133], v[104:105], v[106:107]
  v_pk_add_f32 v[134:135], v[108:109], v[110:111]
  v_pk_add_f32 v[136:137], v[112:113], v[114:115]
  v_pk_add_f32 v[138:139], v[116:117], v[118:119]
  v_pk_add_f32 v[140:141], v[120:121], v[122:123]
  v_pk_add_f32 v[142:143], v[124:125], v[126:127]
  v_pk_add_f32 v[128:129], v[128:129], v[130:131]
  v_pk_add_f32 v[128:129], v[128:129], v[132:133]
  v_pk_add_f32 v[128:129], v[128:129], v[134:135]
  v_pk_add_f32 v[128:129], v[128:129], v[136:137]
  v_pk_add_f32 v[128:129], v[128:129], v[138:139]
  v_pk_add_f32 v[128:129], v[128:129], v[140:141]
  v_pk_add_f32 v[128:129], v[128:129], v[142:143]
  v_add_f32 v14, v128, v129
  s_nop 1
  v_add_f32_dpp v14, v14, v14 row_ror:8 row_mask:0xf bank_mask:0xf
  s_nop 1
  v_add_f32_dpp v14, v14, v14 row_ror:4 row_mask:0xf bank_mask:0xf
  s_nop 1
  v_add_f32_dpp v14, v14, v14 row_ror:2 row_mask:0xf bank_mask:0xf
  s_nop 1
  v_add_f32_dpp v14, v14, v14 row_ror:1 row_mask:0xf bank_mask:0xf
  v_mul_f32 v14, 0x3b000000, v14
  v_sub_f32 v96, v96, v14
  v_sub_f32 v97, v97, v14
  v_sub_f32 v98, v98, v14
  v_sub_f32 v99, v99, v14
  v_sub_f32 v100, v100, v14
  v_sub_f32 v101, v101, v14
  v_sub_f32 v102, v102, v14
  v_sub_f32 v103, v103, v14
  v_sub_f32 v104, v104, v14
  v_sub_f32 v105, v105, v14
  v_sub_f32 v106, v106, v14
  v_sub_f32 v107, v107, v14
  v_sub_f32 v108, v108, v14
  v_sub_f32 v109, v109, v14
  v_sub_f32 v110, v110, v14
  v_sub_f32 v111, v111, v14
  v_sub_f32 v112, v112, v14
  v_sub_f32 v113, v113, v14
  v_sub_f32 v114, v114, v14
  v_sub_f32 v115, v115, v14
  v_sub_f32 v116, v116, v14
  v_sub_f32 v117, v117, v14
  v_sub_f32 v118, v118, v14
  v_sub_f32 v119, v119, v14
  v_sub_f32 v120, v120, v14
  v_sub_f32 v121, v121, v14
  v_sub_f32 v122, v122, v14
  v_sub_f32 v123, v123, v14
  v_sub_f32 v124, v124, v14
  v_sub_f32 v125, v125, v14
  v_sub_f32 v126, v126, v14
  v_sub_f32 v127, v127, v14
  v_mul_f32 v15, v96, v96
  v_mul_f32 v16, v97, v97
  v_fmac_f32 v15, v98, v98
  v_fmac_f32 v16, v99, v99
  v_fmac_f32 v15, v100, v100
  v_fmac_f32 v16, v101, v101
  v_fmac_f32 v15, v102, v102
  v_fmac_f32 v16, v103, v103
  v_fmac_f32 v15, v104, v104
  v_fmac_f32 v16, v105, v105
  v_fmac_f32 v15, v106, v106
  v_fmac_f32 v16, v107, v107
  v_fmac_f32 v15, v108, v108
  v_fmac_f32 v16, v109, v109
  v_fmac_f32 v15, v110, v110
  v_fmac_f32 v16, v111, v111
  v_fmac_f32 v15, v112, v112
  v_fmac_f32 v16, v113, v113
  v_fmac_f32 v15, v114, v114
  v_fmac_f32 v16, v115, v115
  v_fmac_f32 v15, v116, v116
  v_fmac_f32 v16, v117, v117
  v_fmac_f32 v15, v118, v118
  v_fmac_f32 v16, v119, v119
  v_fmac_f32 v15, v120, v120
  v_fmac_f32 v16, v121, v121
  v_fmac_f32 v15, v122, v122
  v_fmac_f32 v16, v123, v123
  v_fmac_f32 v15, v124, v124
  v_fmac_f32 v16, v125, v125
  v_fmac_f32 v15, v126, v126
  v_fmac_f32 v16, v127, v127
  v_add_f32 v15, v15, v16
  s_nop 1
  v_add_f32_dpp v15, v15, v15 row_ror:8 row_mask:0xf bank_mask:0xf
  s_nop 1
  v_add_f32_dpp v15, v15, v15 row_ror:4 row_mask:0xf bank_mask:0xf
  s_nop 1
  v_add_f32_dpp v15, v15, v15 row_ror:2 row_mask:0xf bank_mask:0xf
  s_nop 1
  v_add_f32_dpp v15, v15, v15 row_ror:1 row_mask:0xf bank_mask:0xf
  v_mul_f32 v15, 0x3b000000, v15
  v_cvt_pk_bf16_f32 v14, 0, v14
  v_cvt_pk_bf16_f32 v15, 0, v15
  v_add_f32 v15, 0x3727c5ac, v15
  v_cvt_pk_bf16_f32 v15, 0, v15
  v_sqrt_f32 v15, v15
  s_nop 0
  v_cvt_pk_bf16_f32 v15, 0, v15
  v_rcp_f32 v15, v15
  v_lshlrev_b32 v84, 16, v80
  v_and_b32 v85, 0xffff0000, v80
  v_lshlrev_b32 v86, 16, v81
  v_and_b32 v87, 0xffff0000, v81
  v_sub_f32 v84, v84, v14
  v_sub_f32 v85, v85, v14
  v_sub_f32 v86, v86, v14
  v_sub_f32 v87, v87, v14
  v_cvt_pk_bf16_f32 v84, 0, v84
  v_cvt_pk_bf16_f32 v85, 0, v85
  v_cvt_pk_bf16_f32 v86, 0, v86
  v_cvt_pk_bf16_f32 v87, 0, v87
  v_mul_f32 v84, v84, v15
  v_mul_f32 v85, v85, v15
  v_mul_f32 v86, v86, v15
  v_mul_f32 v87, v87, v15
  v_cvt_pk_bf16_f32 v84, 0, v84
  v_cvt_pk_bf16_f32 v85, 0, v85
  v_cvt_pk_bf16_f32 v86, 0, v86
  v_cvt_pk_bf16_f32 v87, 0, v87
  v_lshrrev_b32 v8, 1, v2
  v_lshl_add_u32 v8, v3, 4, v8
  v_lshlrev_b32 v8, 4, v8
  v_and_b32 v9, 1, v2
  v_lshl_add_u32 v8, v9, 10, v8
  v_lshlrev_b32 v9, 9, v3
  v_lshl_add_u32 v9, v2, 4, v9
  s_lshr_b32 s88, s37, 1
  s_lshl_b32 s88, s88, 2
  s_add_u32 s88, s88, s38
  s_lshl_b32 s88, s88, 3
  s_and_b32 s89, s37, 1
  s_add_u32 s88, s88, s89
  s_lshl_b32 s88, s88, 8
  s_add_u32 s88, s88, 393216
  s_cmp_eq_u32 s38, 0
  s_cselect_b32 s89, 1.0, 0
  s_add_u32 s84, s98, 1
  v_mov_b32 v28, 0xfffff000
  s_lshr_b32 s13, s84, 12
  s_add_u32 s13, s13, s84
  s_add_u32 s14, s99, s84
  s_lshr_b32 s15, s99, 12
  s_add_u32 s15, s15, s84
  s_and_b32 s12, s84, 0xfff
  s_and_b32 s13, s13, 0xfff
  s_and_b32 s14, s14, 0xfff
  s_and_b32 s15, s15, 0xfff
  s_mov_b32 s90, 800000
  v_mov_b32 v25, 0
L_lsp_96:
  ds_read_b32 v24, v25 offset:0
  s_waitcnt lgkmcnt(0)
  v_readfirstlane_b32 s91, v24
  s_cmp_ge_u32 s91, 4
  s_cbranch_scc1 L_ldone_97
  s_sub_u32 s90, s90, 1
  s_cmp_lg_u32 s90, 0
  s_cbranch_scc1 L_lsp_96
L_ldone_97:
  ds_read_b128 v[32:35], v8 offset:2048
  ds_read_b128 v[36:39], v8 offset:2176
  ds_read_b128 v[40:43], v8 offset:4096
  ds_read_b128 v[44:47], v8 offset:4224
  ds_read_b128 v[48:51], v8 offset:6144
  ds_read_b128 v[52:55], v8 offset:6272
  ds_read_b128 v[56:59], v8 offset:8192
  ds_read_b128 v[60:63], v8 offset:8320
  s_waitcnt lgkmcnt(0)
  v_pk_add_f32 v[32:33], v[32:33], v[40:41]
  v_pk_add_f32 v[34:35], v[34:35], v[42:43]
  v_pk_add_f32 v[36:37], v[36:37], v[44:45]
  v_pk_add_f32 v[38:39], v[38:39], v[46:47]
  v_pk_add_f32 v[32:33], v[32:33], v[48:49]
  v_pk_add_f32 v[34:35], v[34:35], v[50:51]
  v_pk_add_f32 v[36:37], v[36:37], v[52:53]
  v_pk_add_f32 v[38:39], v[38:39], v[54:55]
  v_pk_add_f32 v[32:33], v[32:33], v[56:57]
  v_pk_add_f32 v[34:35], v[34:35], v[58:59]
  v_pk_add_f32 v[36:37], v[36:37], v[60:61]
  v_pk_add_f32 v[38:39], v[38:39], v[62:63]
  v_add_f32 v36, s89, v36
  v_add_f32 v37, s89, v37
  v_add_f32 v38, s89, v38
  v_add_f32 v39, s89, v39
  v_fmac_f32 v32, v36, v84
  v_fmac_f32 v33, v37, v85
  v_fmac_f32 v34, v38, v86
  v_fmac_f32 v35, v39, v87
  v_add_u32 v32, 0x800, v32
  v_add_u32 v33, 0x800, v33
  v_add_u32 v34, 0x800, v34
  v_add_u32 v35, 0x800, v35
  v_and_or_b32 v32, v32, v28, s12
  v_and_or_b32 v33, v33, v28, s13
  v_and_or_b32 v34, v34, v28, s14
  v_and_or_b32 v35, v35, v28, s15
  buffer_store_dwordx4 v[32:35], v9, s[44:47], s88 offen sc1
L_Mret:
  s_setprio 0
  s_branch L_S
L_Q1:
  s_cmp_lg_u32 s35, 1
  s_cbranch_scc1 L_noQ1
  v_lshrrev_b32 v10, 3, v1
  v_lshlrev_b32 v10, 16, v10
  v_and_b32 v9, 7, v1
  v_lshl_add_u32 v10, v9, 4, v10
  s_lshr_b32 s37, s33, 1
  s_lshl_b32 s94, s37, 20
  s_lshl_b32 s89, s31, 8
  s_add_u32 s94, s94, s89
  s_lshl_b32 s89, s32, 7
  s_add_u32 s94, s94, s89
  s_add_u32 s89, s94, 0
  buffer_load_dwordx4 v[192:195], v10, s[52:55], s89 offen nt
  s_add_u32 s89, s94, 8192
  buffer_load_dwordx4 v[196:199], v10, s[52:55], s89 offen nt
  s_add_u32 s89, s94, 16384
  buffer_load_dwordx4 v[200:203], v10, s[52:55], s89 offen nt
  s_add_u32 s89, s94, 24576
  buffer_load_dwordx4 v[204:207], v10, s[52:55], s89 offen nt
  s_add_u32 s89, s94, 32768
  buffer_load_dwordx4 v[208:211], v10, s[52:55], s89 offen nt
  s_add_u32 s89, s94, 40960
  buffer_load_dwordx4 v[212:215], v10, s[52:55], s89 offen nt
  s_add_u32 s89, s94, 49152
  buffer_load_dwordx4 v[216:219], v10, s[52:55], s89 offen nt
  s_add_u32 s89, s94, 57344
  buffer_load_dwordx4 v[220:223], v10, s[52:55], s89 offen nt
  s_add_u32 s89, s94, 524288
  buffer_load_dwordx4 v[224:227], v10, s[52:55], s89 offen nt
  s_add_u32 s89, s94, 532480
  buffer_load_dwordx4 v[228:231], v10, s[52:55], s89 offen nt
  s_add_u32 s89, s94, 540672
  buffer_load_dwordx4 v[232:235], v10, s[52:55], s89 offen nt
  s_add_u32 s89, s94, 548864
  buffer_load_dwordx4 v[236:239], v10, s[52:55], s89 offen nt
  s_add_u32 s89, s94, 557056
  buffer_load_dwordx4 v[240:243], v10, s[52:55], s89 offen nt
  s_add_u32 s89, s94, 565248
  buffer_load_dwordx4 v[244:247], v10, s[52:55], s89 offen nt
  s_add_u32 s89, s94, 573440
  buffer_load_dwordx4 v[248:251], v10, s[52:55], s89 offen nt
  s_add_u32 s89, s94, 581632
  buffer_load_dwordx4 v[252:255], v10, s[52:55], s89 offen nt
L_noQ1:
  s_waitcnt lgkmcnt(0)
  s_add_u32 s84, s98, 1
  s_mov_b32 s85, s99
  s_lshr_b32 s13, s84, 12
  s_add_u32 s13, s13, s84
  s_add_u32 s14, s99, s84
  s_lshr_b32 s15, s99, 12
  s_add_u32 s15, s15, s84
  s_and_b32 s12, s84, 0xfff
  s_and_b32 s13, s13, 0xfff
  s_and_b32 s14, s14, 0xfff
  s_and_b32 s15, s15, 0xfff
  s_cmp_lg_u32 s35, 1
  s_cbranch_scc1 L_noQ2
  v_mov_b32 v28, 0xfffff000
  s_lshl_b32 s88, s37, 13
  s_add_u32 s88, s88, 393216
  s_add_u32 s89, s88, 4096
  s_cmp_lt_u32 s2, 32
  s_cselect_b32 s94, 24, 40
  v_lshrrev_b32 v8, 5, v1
  v_mul_u32_u24 v8, 272, v8
  v_and_b32 v10, 31, v1
  v_lshl_add_u32 v8, v10, 3, v8
  v_mul_u32_u24 v10, 272, v6
  v_lshl_add_u32 v10, v3, 5, v10
  v_and_b32 v12, 1, v2
  v_lshl_add_u32 v10, v12, 4, v10
  v_lshlrev_b32 v29, 11, v3
  v_lshl_add_u32 v29, v2, 4, v29
  v_lshrrev_b32 v30, 3, v2
  v_lshl_add_u32 v30, v9, 1, v30
  v_lshlrev_b32 v30, 3, v30
  v_lshl_add_u32 v30, v3, 7, v30
  s_waitcnt vmcnt(0)
  v_perm_b32 v64, v196, v192, s86
  v_perm_b32 v65, v204, v200, s86
  v_perm_b32 v66, v212, v208, s86
  v_perm_b32 v67, v220, v216, s86
  v_perm_b32 v68, v196, v192, s87
  v_perm_b32 v69, v204, v200, s87
  v_perm_b32 v70, v212, v208, s87
  v_perm_b32 v71, v220, v216, s87
  v_perm_b32 v72, v197, v193, s86
  v_perm_b32 v73, v205, v201, s86
  v_perm_b32 v74, v213, v209, s86
  v_perm_b32 v75, v221, v217, s86
  v_perm_b32 v76, v197, v193, s87
  v_perm_b32 v77, v205, v201, s87
  v_perm_b32 v78, v213, v209, s87
  v_perm_b32 v79, v221, v217, s87
  v_perm_b32 v80, v198, v194, s86
  v_perm_b32 v81, v206, v202, s86
  v_perm_b32 v82, v214, v210, s86
  v_perm_b32 v83, v222, v218, s86
  v_perm_b32 v84, v198, v194, s87
  v_perm_b32 v85, v206, v202, s87
  v_perm_b32 v86, v214, v210, s87
  v_perm_b32 v87, v222, v218, s87
  v_perm_b32 v88, v199, v195, s86
  v_perm_b32 v89, v207, v203, s86
  v_perm_b32 v90, v215, v211, s86
  v_perm_b32 v91, v223, v219, s86
  v_perm_b32 v92, v199, v195, s87
  v_perm_b32 v93, v207, v203, s87
  v_perm_b32 v94, v215, v211, s87
  v_perm_b32 v95, v223, v219, s87
  v_perm_b32 v96, v228, v224, s86
  v_perm_b32 v97, v236, v232, s86
  v_perm_b32 v98, v244, v240, s86
  v_perm_b32 v99, v252, v248, s86
  v_perm_b32 v100, v228, v224, s87
  v_perm_b32 v101, v236, v232, s87
  v_perm_b32 v102, v244, v240, s87
  v_perm_b32 v103, v252, v248, s87
  v_perm_b32 v104, v229, v225, s86
  v_perm_b32 v105, v237, v233, s86
  v_perm_b32 v106, v245, v241, s86
  v_perm_b32 v107, v253, v249, s86
  v_perm_b32 v108, v229, v225, s87
  v_perm_b32 v109, v237, v233, s87
  v_perm_b32 v110, v245, v241, s87
  v_perm_b32 v111, v253, v249, s87
  v_perm_b32 v112, v230, v226, s86
  v_perm_b32 v113, v238, v234, s86
  v_perm_b32 v114, v246, v242, s86
  v_perm_b32 v115, v254, v250, s86
  v_perm_b32 v116, v230, v226, s87
  v_perm_b32 v117, v238, v234, s87
  v_perm_b32 v118, v246, v242, s87
  v_perm_b32 v119, v254, v250, s87
  v_perm_b32 v120, v231, v227, s86
  v_perm_b32 v121, v239, v235, s86
  v_perm_b32 v122, v247, v243, s86
  v_perm_b32 v123, v255, v251, s86
  v_perm_b32 v124, v231, v227, s87
  v_perm_b32 v125, v239, v235, s87
  v_perm_b32 v126, v247, v243, s87
  v_perm_b32 v127, v255, v251, s87
  s_mov_b32 s90, 800000
  v_mov_b32 v13, 0
L_lsp_98:
  ds_read_b32 v12, v13 offset:12
  s_waitcnt lgkmcnt(0)
  v_readfirstlane_b32 s91, v12
  s_cmp_ge_u32 s91, s94
  s_cbranch_scc1 L_ldone_99
  s_sleep 2
  s_sub_u32 s90, s90, 1
  s_cmp_lg_u32 s90, 0
  s_cbranch_scc1 L_lsp_98
L_ldone_99:
  s_mov_b32 s90, 200000
L_poll_100:
  buffer_load_dwordx4 v[128:131], v7, s[44:47], s88 offen offset:0 sc1
  buffer_load_dwordx4 v[132:135], v7, s[44:47], s88 offen offset:1024 sc1
  buffer_load_dwordx4 v[136:139], v7, s[44:47], s88 offen offset:2048 sc1
  buffer_load_dwordx4 v[140:143], v7, s[44:47], s88 offen offset:3072 sc1
  buffer_load_dwordx4 v[144:147], v7, s[44:47], s89 offen offset:0 sc1
  buffer_load_dwordx4 v[148:151], v7, s[44:47], s89 offen offset:1024 sc1
  buffer_load_dwordx4 v[152:155], v7, s[44:47], s89 offen offset:2048 sc1
  buffer_load_dwordx4 v[156:159], v7, s[44:47], s89 offen offset:3072 sc1
  s_waitcnt vmcnt(0)
  v_xor_b32 v128, s12, v128
  v_xor_b32 v129, s13, v129
  v_xor_b32 v130, s14, v130
  v_xor_b32 v131, s15, v131
  v_xor_b32 v132, s12, v132
  v_xor_b32 v133, s13, v133
  v_xor_b32 v134, s14, v134
  v_xor_b32 v135, s15, v135
  v_xor_b32 v136, s12, v136
  v_xor_b32 v137, s13, v137
  v_xor_b32 v138, s14, v138
  v_xor_b32 v139, s15, v139
  v_xor_b32 v140, s12, v140
  v_xor_b32 v141, s13, v141
  v_xor_b32 v142, s14, v142
  v_xor_b32 v143, s15, v143
  v_xor_b32 v144, s12, v144
  v_xor_b32 v145, s13, v145
  v_xor_b32 v146, s14, v146
  v_xor_b32 v147, s15, v147
  v_xor_b32 v148, s12, v148
  v_xor_b32 v149, s13, v149
  v_xor_b32 v150, s14, v150
  v_xor_b32 v151, s15, v151
  v_xor_b32 v152, s12, v152
  v_xor_b32 v153, s13, v153
  v_xor_b32 v154, s14, v154
  v_xor_b32 v155, s15, v155
  v_xor_b32 v156, s12, v156
  v_xor_b32 v157, s13, v157
  v_xor_b32 v158, s14, v158
  v_xor_b32 v159, s15, v159
  v_or_b32 v12, v128, v129
  v_or3_b32 v12, v12, v130, v131
  v_or3_b32 v12, v12, v132, v133
  v_or3_b32 v12, v12, v134, v135
  v_or3_b32 v12, v12, v136, v137
  v_or3_b32 v12, v12, v138, v139
  v_or3_b32 v12, v12, v140, v141
  v_or3_b32 v12, v12, v142, v143
  v_or3_b32 v12, v12, v144, v145
  v_or3_b32 v12, v12, v146, v147
  v_or3_b32 v12, v12, v148, v149
  v_or3_b32 v12, v12, v150, v151
  v_or3_b32 v12, v12, v152, v153
  v_or3_b32 v12, v12, v154, v155
  v_or3_b32 v12, v12, v156, v157
  v_or3_b32 v12, v12, v158, v159
  v_and_b32 v12, 0xfff, v12
  v_cmp_ne_u32 vcc, 0, v12
  s_cbranch_vccz L_pdone_101
  s_sleep 8
  s_sub_u32 s90, s90, 1
  s_cmp_lg_u32 s90, 0
  s_cbranch_scc1 L_poll_100
L_pdone_101:
  v_pk_add_f32 v[128:129], v[128:129], v[136:137]
  v_pk_add_f32 v[130:131], v[130:131], v[138:139]
  v_pk_add_f32 v[132:133], v[132:133], v[140:141]
  v_pk_add_f32 v[134:135], v[134:135], v[142:143]
  v_pk_add_f32 v[128:129], v[128:129], v[144:145]
  v_pk_add_f32 v[130:131], v[130:131], v[146:147]
  v_pk_add_f32 v[132:133], v[132:133], v[148:149]
  v_pk_add_f32 v[134:135], v[134:135], v[150:151]
  v_pk_add_f32 v[128:129], v[128:129], v[152:153]
  v_pk_add_f32 v[130:131], v[130:131], v[154:155]
  v_pk_add_f32 v[132:133], v[132:133], v[156:157]
  v_pk_add_f32 v[134:135], v[134:135], v[158:159]
  v_cvt_pk_bf16_f32 v20, v128, v129
  v_cvt_pk_bf16_f32 v21, v130, v131
  v_cvt_pk_bf16_f32 v24, v132, v133
  v_cvt_pk_bf16_f32 v25, v134, v135
  ds_write_b64 v8, v[20:21] offset:512
  ds_write_b64 v8, v[24:25] offset:1056
  s_lshl_b32 s88, s31, 13
  s_add_u32 s88, s88, 458752
  s_lshl_b32 s89, s33, 8
  s_add_u32 s89, s89, s88
  s_waitcnt lgkmcnt(0)
  ds_read_b128 v[20:23], v10 offset:512
  ds_read_b128 v[24:27], v10 offset:640
  s_waitcnt lgkmcnt(0)
  v_mfma_f32_16x16x32_bf16 v[32:35], v[20:23], v[64:67], 0
  v_mfma_f32_16x16x32_bf16 v[36:39], v[20:23], v[68:71], 0
  v_mfma_f32_16x16x32_bf16 v[40:43], v[20:23], v[72:75], 0
  v_mfma_f32_16x16x32_bf16 v[44:47], v[20:23], v[76:79], 0
  v_mfma_f32_16x16x32_bf16 v[48:51], v[20:23], v[80:83], 0
  v_mfma_f32_16x16x32_bf16 v[52:55], v[20:23], v[84:87], 0
  v_mfma_f32_16x16x32_bf16 v[56:59], v[20:23], v[88:91], 0
  v_mfma_f32_16x16x32_bf16 v[60:63], v[20:23], v[92:95], 0
  v_mfma_f32_16x16x32_bf16 v[32:35], v[24:27], v[96:99], v[32:35]
  v_mfma_f32_16x16x32_bf16 v[36:39], v[24:27], v[100:103], v[36:39]
  v_mfma_f32_16x16x32_bf16 v[40:43], v[24:27], v[104:107], v[40:43]
  v_mfma_f32_16x16x32_bf16 v[44:47], v[24:27], v[108:111], v[44:47]
  v_mfma_f32_16x16x32_bf16 v[48:51], v[24:27], v[112:115], v[48:51]
  v_mfma_f32_16x16x32_bf16 v[52:55], v[24:27], v[116:119], v[52:55]
  v_mfma_f32_16x16x32_bf16 v[56:59], v[24:27], v[120:123], v[56:59]
  v_mfma_f32_16x16x32_bf16 v[60:63], v[24:27], v[124:127], v[60:63]
  s_nop 0
  v_add_f32_dpp v16, v33, v32 row_ror:8 row_mask:0xf bank_mask:0x3
  v_add_f32_dpp v17, v37, v36 row_ror:8 row_mask:0xf bank_mask:0x3
  v_add_f32_dpp v18, v41, v40 row_ror:8 row_mask:0xf bank_mask:0x3
  v_add_f32_dpp v19, v45, v44 row_ror:8 row_mask:0xf bank_mask:0x3
  v_add_f32_dpp v16, v48, v49 row_ror:8 row_mask:0xf bank_mask:0xc
  v_add_f32_dpp v17, v52, v53 row_ror:8 row_mask:0xf bank_mask:0xc
  v_add_f32_dpp v18, v56, v57 row_ror:8 row_mask:0xf bank_mask:0xc
  v_add_f32_dpp v19, v60, v61 row_ror:8 row_mask:0xf bank_mask:0xc
  v_add_u32 v16, 0x800, v16
  v_add_u32 v17, 0x800, v17
  v_add_u32 v18, 0x800, v18
  v_add_u32 v19, 0x800, v19
  v_and_or_b32 v16, v16, v28, s12
  v_and_or_b32 v17, v17, v28, s13
  v_and_or_b32 v18, v18, v28, s14
  v_and_or_b32 v19, v19, v28, s15
  buffer_store_dwordx4 v[16:19], v29, s[44:47], s89 offen sc1
  s_lshl_b32 s89, s30, 11
  s_add_u32 s88, s88, s89
  s_waitcnt vmcnt(0)
  s_mov_b32 s90, 800000
  v_mov_b32 v13, 0
L_lsp_102:
  ds_read_b32 v12, v13 offset:12
  s_waitcnt lgkmcnt(0)
  v_readfirstlane_b32 s91, v12
  s_cmp_ge_u32 s91, 70
  s_cbranch_scc1 L_ldone_103
  s_sleep 2
  s_sub_u32 s90, s90, 1
  s_cmp_lg_u32 s90, 0
  s_cbranch_scc1 L_lsp_102
L_ldone_103:
  s_mov_b32 s90, 200000
L_poll_104:
  buffer_load_dwordx4 v[20:23], v7, s[44:47], s88 offen sc1
  buffer_load_dwordx4 v[24:27], v7, s[44:47], s88 offen offset:1024 sc1
  s_waitcnt vmcnt(0)
  v_xor_b32 v20, s12, v20
  v_xor_b32 v21, s13, v21
  v_xor_b32 v22, s14, v22
  v_xor_b32 v23, s15, v23
  v_xor_b32 v24, s12, v24
  v_xor_b32 v25, s13, v25
  v_xor_b32 v26, s14, v26
  v_xor_b32 v27, s15, v27
  v_or3_b32 v12, v20, v21, v22
  v_or3_b32 v13, v23, v24, v25
  v_or3_b32 v12, v12, v26, v27
  v_or_b32 v12, v12, v13
  v_and_b32 v12, 0xfff, v12
  v_cmp_ne_u32 vcc, 0, v12
  s_cbranch_vccz L_pdone_105
  s_sleep 4
  s_sub_u32 s90, s90, 1
  s_cmp_lg_u32 s90, 0
  s_cbranch_scc1 L_poll_104
L_pdone_105:
  v_add_f32 v20, v20, v24
  v_add_f32 v21, v21, v25
  v_add_f32 v22, v22, v26
  v_add_f32 v23, v23, v27
  v_mov_b32 v24, v20
  v_mov_b32 v25, v21
  v_mov_b32 v26, v22
  v_mov_b32 v27, v23
  v_permlane32_swap_b32 v20, v24
  v_permlane32_swap_b32 v21, v25
  v_permlane32_swap_b32 v22, v26
  v_permlane32_swap_b32 v23, v27
  v_add_f32 v20, v20, v24
  v_add_f32 v21, v21, v25
  v_add_f32 v22, v22, v26
  v_add_f32 v23, v23, v27
  v_cvt_pk_bf16_f32 v20, v20, v21
  v_cvt_pk_bf16_f32 v21, v22, v23
  s_mov_b32 exec_hi, 0
  ds_write_b64 v30, v[20:21] offset:256
  s_mov_b32 exec_hi, -1
L_noQ2:
  s_waitcnt vmcnt(0) lgkmcnt(0)
  s_barrier
  s_lshl_b32 s95, s35, 12
  v_add_u32 v11, s95, v7
  s_branch L_WO
L_afterWO:
  s_cmp_lg_u32 s35, 0
  s_cbranch_scc1 L_noP
  s_mov_b32 s90, 800000
  v_mov_b32 v15, 0
L_lsp_106:
  ds_read_b32 v14, v15 offset:4
  s_waitcnt lgkmcnt(0)
  v_readfirstlane_b32 s91, v14
  s_cmp_ge_u32 s91, 4
  s_cbranch_scc1 L_ldone_107
  s_sleep 4
  s_sub_u32 s90, s90, 1
  s_cmp_lg_u32 s90, 0
  s_cbranch_scc1 L_lsp_106
L_ldone_107:
  ds_read_b128 v[16:19], v15 offset:64
  ds_read_b128 v[20:23], v15 offset:80
  s_waitcnt lgkmcnt(0)
  v_max3_f32 v24, v16, v18, v20
  v_max_f32 v24, v24, v22
  v_sub_f32 v32, v16, v24
  v_exp_f32 v32, v32
  v_sub_f32 v33, v18, v24
  v_exp_f32 v33, v33
  v_sub_f32 v34, v20, v24
  v_exp_f32 v34, v34
  v_sub_f32 v35, v22, v24
  v_exp_f32 v35, v35
  v_mul_f32 v25, v32, v17
  v_fmac_f32 v25, v33, v19
  v_fmac_f32 v25, v34, v21
  v_fmac_f32 v25, v35, v23
  v_mov_b32 v26, s84
  v_mov_b32 v27, s85
  s_lshl_b32 s88, s2, 4
  s_add_u32 s88, s88, 65536
  s_mov_b64 exec, 1
  buffer_store_dwordx4 v[24:27], v15, s[44:47], s88 offen sc1
  ds_write_b128 v15, v[32:35] offset:128
  ds_write_b64 v15, v[24:25] offset:144
  s_waitcnt lgkmcnt(0)
  s_mov_b64 exec, -1
L_noP:
  s_sub_u32 s88, s2, 32
  s_cmp_lt_u32 s88, 32
  s_cbranch_scc1 L_M
L_afterM:
  s_cmp_ge_u32 s36, 56
  s_cbranch_scc1 L_noF1
  s_mov_b32 s90, 800000
  v_mov_b32 v15, 0
L_lsp_108:
  ds_read_b32 v14, v15 offset:4
  s_waitcnt lgkmcnt(0)
  v_readfirstlane_b32 s91, v14
  s_cmp_ge_u32 s91, 4
  s_cbranch_scc1 L_ldone_109
  s_sleep 4
  s_sub_u32 s90, s90, 1
  s_cmp_lg_u32 s90, 0
  s_cbranch_scc1 L_lsp_108
L_ldone_109:
  v_lshrrev_b32 v8, 2, v1
  v_mul_u32_u24 v8, 3584, v8
  v_and_b32 v9, 3, v1
  v_lshl_add_u32 v8, v9, 4, v8
  s_mul_i32 s94, s35, 458752
  s_lshl_b32 s89, s36, 6
  s_add_u32 s94, s94, s89
  s_lshl_b32 s37, s35, 13
  s_add_u32 s37, s37, 32768
  v_lshl_add_u32 v9, v3, 9, s37
  v_lshl_add_u32 v9, v2, 2, v9
  s_add_u32 m0, s37, 0
  s_add_u32 s89, s94, 0
  buffer_load_dwordx4 v8, s[60:63], s89 offen nt lds
  s_add_u32 m0, s37, 1024
  s_add_u32 s89, s94, 57344
  buffer_load_dwordx4 v8, s[60:63], s89 offen nt lds
  s_add_u32 m0, s37, 2048
  s_add_u32 s89, s94, 114688
  buffer_load_dwordx4 v8, s[60:63], s89 offen nt lds
  s_waitcnt vmcnt(2)
  s_add_u32 m0, s37, 3072
  s_add_u32 s89, s94, 172032
  buffer_load_dwordx4 v8, s[60:63], s89 offen nt lds
  s_waitcnt vmcnt(2)
  s_add_u32 m0, s37, 4096
  s_add_u32 s89, s94, 229376
  buffer_load_dwordx4 v8, s[60:63], s89 offen nt lds
  s_waitcnt vmcnt(2)
  s_add_u32 m0, s37, 5120
  s_add_u32 s89, s94, 286720
  buffer_load_dwordx4 v8, s[60:63], s89 offen nt lds
  s_waitcnt vmcnt(2)
  s_add_u32 m0, s37, 6144
  s_add_u32 s89, s94, 344064
  buffer_load_dwordx4 v8, s[60:63], s89 offen nt lds
  s_waitcnt vmcnt(2)
  s_add_u32 m0, s37, 7168
  s_add_u32 s89, s94, 401408
  buffer_load_dwordx4 v8, s[60:63], s89 offen nt lds
  v_lshlrev_b32 v8, 13, v3
  v_lshl_add_u32 v8, v2, 4, v8
  s_lshl_b32 s94, s36, 15
  s_lshl_b32 s89, s35, 8
  s_add_u32 s94, s94, s89
  s_add_u32 s89, s94, 4096
  s_waitcnt vmcnt(2)
  buffer_load_dwordx4 v[32:35], v8, s[64:67], s94 offen offset:0 nt
  s_waitcnt vmcnt(2)
  buffer_load_dwordx4 v[36:39], v8, s[64:67], s94 offen offset:1024 nt
  s_waitcnt vmcnt(2)
  buffer_load_dwordx4 v[40:43], v8, s[64:67], s94 offen offset:2048 nt
  s_waitcnt vmcnt(2)
  buffer_load_dwordx4 v[44:47], v8, s[64:67], s94 offen offset:3072 nt
  s_waitcnt vmcnt(2)
  buffer_load_dwordx4 v[48:51], v8, s[64:67], s89 offen offset:0 nt
  s_waitcnt vmcnt(2)
  buffer_load_dwordx4 v[52:55], v8, s[64:67], s89 offen offset:1024 nt
  s_waitcnt vmcnt(2)
  buffer_load_dwordx4 v[56:59], v8, s[64:67], s89 offen offset:2048 nt
  s_waitcnt vmcnt(2)
  buffer_load_dwordx4 v[60:63], v8, s[64:67], s89 offen offset:3072 nt
  s_waitcnt vmcnt(0)
  ds_read_b32 v224, v9 offset:0
  ds_read_b32 v225, v9 offset:64
  ds_read_b32 v226, v9 offset:128
  ds_read_b32 v227, v9 offset:192
  ds_read_b32 v228, v9 offset:256
  ds_read_b32 v229, v9 offset:320
  ds_read_b32 v230, v9 offset:384
  ds_read_b32 v231, v9 offset:448
  s_waitcnt lgkmcnt(0)
  ds_read_b32 v232, v9 offset:2048
  ds_read_b32 v233, v9 offset:2112
  ds_read_b32 v234, v9 offset:2176
  ds_read_b32 v235, v9 offset:2240
  ds_read_b32 v236, v9 offset:2304
  ds_read_b32 v237, v9 offset:2368
  ds_read_b32 v238, v9 offset:2432
  ds_read_b32 v239, v9 offset:2496
  s_waitcnt lgkmcnt(0)
  ds_read_b32 v240, v9 offset:4096
  ds_read_b32 v241, v9 offset:4160
  ds_read_b32 v242, v9 offset:4224
  ds_read_b32 v243, v9 offset:4288
  ds_read_b32 v244, v9 offset:4352
  ds_read_b32 v245, v9 offset:4416
  ds_read_b32 v246, v9 offset:4480
  ds_read_b32 v247, v9 offset:4544
  s_waitcnt lgkmcnt(0)
  ds_read_b32 v248, v9 offset:6144
  ds_read_b32 v249, v9 offset:6208
  ds_read_b32 v250, v9 offset:6272
  ds_read_b32 v251, v9 offset:6336
  ds_read_b32 v252, v9 offset:6400
  ds_read_b32 v253, v9 offset:6464
  ds_read_b32 v254, v9 offset:6528
  ds_read_b32 v255, v9 offset:6592
  s_waitcnt lgkmcnt(0)
  v_perm_b32 v192, v225, v224, s86
  v_perm_b32 v193, v227, v226, s86
  v_perm_b32 v194, v229, v228, s86
  v_perm_b32 v195, v231, v230, s86
  v_perm_b32 v196, v225, v224, s87
  v_perm_b32 v197, v227, v226, s87
  v_perm_b32 v198, v229, v228, s87
  v_perm_b32 v199, v231, v230, s87
  v_perm_b32 v200, v233, v232, s86
  v_perm_b32 v201, v235, v234, s86
  v_perm_b32 v202, v237, v236, s86
  v_perm_b32 v203, v239, v238, s86
  v_perm_b32 v204, v233, v232, s87
  v_perm_b32 v205, v235, v234, s87
  v_perm_b32 v206, v237, v236, s87
  v_perm_b32 v207, v239, v238, s87
  v_perm_b32 v208, v241, v240, s86
  v_perm_b32 v209, v243, v242, s86
  v_perm_b32 v210, v245, v244, s86
  v_perm_b32 v211, v247, v246, s86
  v_perm_b32 v212, v241, v240, s87
  v_perm_b32 v213, v243, v242, s87
  v_perm_b32 v214, v245, v244, s87
  v_perm_b32 v215, v247, v246, s87
  v_perm_b32 v216, v249, v248, s86
  v_perm_b32 v217, v251, v250, s86
  v_perm_b32 v218, v253, v252, s86
  v_perm_b32 v219, v255, v254, s86
  v_perm_b32 v220, v249, v248, s87
  v_perm_b32 v221, v251, v250, s87
  v_perm_b32 v222, v253, v252, s87
  v_perm_b32 v223, v255, v254, s87
  v_perm_b32 v224, v36, v32, s86
  v_perm_b32 v225, v44, v40, s86
  v_perm_b32 v226, v52, v48, s86
  v_perm_b32 v227, v60, v56, s86
  v_perm_b32 v228, v36, v32, s87
  v_perm_b32 v229, v44, v40, s87
  v_perm_b32 v230, v52, v48, s87
  v_perm_b32 v231, v60, v56, s87
  v_perm_b32 v232, v37, v33, s86
  v_perm_b32 v233, v45, v41, s86
  v_perm_b32 v234, v53, v49, s86
  v_perm_b32 v235, v61, v57, s86
  v_perm_b32 v236, v37, v33, s87
  v_perm_b32 v237, v45, v41, s87
  v_perm_b32 v238, v53, v49, s87
  v_perm_b32 v239, v61, v57, s87
  v_perm_b32 v240, v38, v34, s86
  v_perm_b32 v241, v46, v42, s86
  v_perm_b32 v242, v54, v50, s86
  v_perm_b32 v243, v62, v58, s86
  v_perm_b32 v244, v38, v34, s87
  v_perm_b32 v245, v46, v42, s87
  v_perm_b32 v246, v54, v50, s87
  v_perm_b32 v247, v62, v58, s87
  v_perm_b32 v248, v39, v35, s86
  v_perm_b32 v249, v47, v43, s86
  v_perm_b32 v250, v55, v51, s86
  v_perm_b32 v251, v63, v59, s86
  v_perm_b32 v252, v39, v35, s87
  v_perm_b32 v253, v47, v43, s87
  v_perm_b32 v254, v55, v51, s87
  v_perm_b32 v255, v63, v59, s87
L_noF1:
  s_cmp_lg_u32 s35, 2
  s_cbranch_scc1 L_noRk
  s_mov_b32 s90, 800000
  v_mov_b32 v13, 0
L_lsp_110:
  ds_read_b32 v12, v13 offset:12
  s_waitcnt lgkmcnt(0)
  v_readfirstlane_b32 s91, v12
  s_cmp_ge_u32 s91, 200
  s_cbranch_scc1 L_ldone_111
  s_sleep 4
  s_sub_u32 s90, s90, 1
  s_cmp_lg_u32 s90, 0
  s_cbranch_scc1 L_lsp_110
L_ldone_111:
  v_mov_b32 v34, s84
  v_mov_b32 v35, s85
  s_lshl_b32 s88, s2, 3
  s_add_u32 s88, s88, 73728
  s_mov_b64 exec, 1
  buffer_store_dwordx2 v[34:35], v13, s[44:47], s88 offen sc1
  s_andn2_b32 s88, s88, 127
  s_and_b32 s89, s2, 15
  s_lshl_b32 s89, 1, s89
  s_andn2_b32 exec_lo, 0xffff, s89
  v_lshlrev_b32 v14, 3, v1
  buffer_load_dwordx2 v[32:33], v14, s[44:47], s88 offen sc1
  s_waitcnt vmcnt(0)
  v_cmp_eq_u64 vcc, s[84:85], v[32:33]
  s_mov_b64 exec, -1
  s_bcnt1_i32_b64 s89, vcc
  s_sub_i32 s89, s89, -3
  s_mul_i32 s89, s89, 3
  s_max_i32 s89, s89, 1
  s_cmp_lt_u32 s36, 56
  s_cselect_b32 s88, 8, 0
  s_add_i32 s89, s89, s88
  s_lshr_b32 s88, s2, 5
  s_cmp_eq_u32 s88, 1
  s_cselect_b32 s88, 4, 0
  s_cmp_lt_u32 s2, 32
  s_cselect_b32 s88, 0, s88
  s_add_i32 s89, s89, s88
  s_or_b32 s89, s89, 1
  v_mov_b32 v14, s89
  ds_write_b32 v13, v14 offset:8
L_noRk:
  s_mov_b32 s90, 800000
  v_mov_b32 v13, 0
L_lsp_112:
  ds_read_b32 v12, v13 offset:12
  s_waitcnt lgkmcnt(0)
  v_readfirstlane_b32 s91, v12
  s_cmp_ge_u32 s91, 208
  s_cbranch_scc1 L_ldone_113
  s_sleep 8
  s_sub_u32 s90, s90, 1
  s_cmp_lg_u32 s90, 0
  s_cbranch_scc1 L_lsp_112
L_ldone_113:
  s_cmp_ge_u32 s36, 56
  s_cbranch_scc1 L_noF1b
  v_lshrrev_b32 v8, 3, v2
  v_and_b32 v9, 2, v3
  v_add_u32 v8, v8, v9
  v_lshlrev_b32 v8, 10, v8
  v_and_b32 v9, 7, v1
  v_lshl_add_u32 v8, v9, 5, v8
  v_and_b32 v9, 1, v3
  v_lshl_add_u32 v8, v9, 4, v8
  v_add_u32 v9, 4096, v8
  s_lshl_b32 s88, s35, 8
  s_add_u32 s89, s88, 36864
  s_add_u32 s88, s88, 28672
  s_mov_b32 s90, 200000
L_poll_114:
  buffer_load_dwordx4 v[32:35], v8, s[44:47], s88 offen sc1
  buffer_load_dwordx4 v[36:39], v9, s[44:47], s88 offen sc1
  buffer_load_dwordx4 v[40:43], v8, s[44:47], s89 offen sc1
  buffer_load_dwordx4 v[44:47], v9, s[44:47], s89 offen sc1
  s_waitcnt vmcnt(0)
  v_cmp_ne_u64 vcc, s[84:85], v[34:35]
  v_cmp_ne_u64 s[92:93], s[84:85], v[38:39]
  s_or_b64 vcc, vcc, s[92:93]
  v_cmp_ne_u64 s[92:93], s[84:85], v[42:43]
  s_or_b64 vcc, vcc, s[92:93]
  v_cmp_ne_u64 s[92:93], s[84:85], v[46:47]
  s_or_b64 vcc, vcc, s[92:93]
  s_cbranch_vccz L_pdone_115
  s_sleep 16
  s_sub_u32 s90, s90, 1
  s_cmp_lg_u32 s90, 0
  s_cbranch_scc1 L_poll_114
L_pdone_115:
  v_lshlrev_b32 v48, 16, v32
  v_and_b32 v49, 0xffff0000, v32
  v_lshlrev_b32 v50, 16, v33
  v_and_b32 v51, 0xffff0000, v33
  v_lshlrev_b32 v52, 16, v36
  v_and_b32 v53, 0xffff0000, v36
  v_lshlrev_b32 v54, 16, v37
  v_and_b32 v55, 0xffff0000, v37
  v_lshlrev_b32 v56, 16, v40
  v_and_b32 v57, 0xffff0000, v40
  v_lshlrev_b32 v58, 16, v41
  v_and_b32 v59, 0xffff0000, v41
  v_lshlrev_b32 v60, 16, v44
  v_and_b32 v61, 0xffff0000, v44
  v_lshlrev_b32 v62, 16, v45
  v_and_b32 v63, 0xffff0000, v45
  v_add_f32 v56, 1.0, v56
  v_add_f32 v57, 1.0, v57
  v_add_f32 v58, 1.0, v58
  v_add_f32 v59, 1.0, v59
  v_add_f32 v60, 1.0, v60
  v_add_f32 v61, 1.0, v61
  v_add_f32 v62, 1.0, v62
  v_add_f32 v63, 1.0, v63
  v_cvt_pk_bf16_f32 v12, v56, v57
  v_lshlrev_b32 v56, 16, v12
  v_and_b32 v57, 0xffff0000, v12
  v_cvt_pk_bf16_f32 v12, v58, v59
  v_lshlrev_b32 v58, 16, v12
  v_and_b32 v59, 0xffff0000, v12
  v_cvt_pk_bf16_f32 v12, v60, v61
  v_lshlrev_b32 v60, 16, v12
  v_and_b32 v61, 0xffff0000, v12
  v_cvt_pk_bf16_f32 v12, v62, v63
  v_lshlrev_b32 v62, 16, v12
  v_and_b32 v63, 0xffff0000, v12
  ds_write_b128 v11, v[48:51] offset:16384
  ds_write_b128 v11, v[52:55] offset:17408
  ds_write_b128 v11, v[56:59] offset:18432
  ds_write_b128 v11, v[60:63] offset:19456
  s_waitcnt lgkmcnt(0)
L_noF1b:
  s_cmp_lg_u32 s35, 0
  s_cbranch_scc1 L_noS
  s_cmp_ge_u32 s40, 64
  s_cbranch_scc1 L_noRc
  s_lshr_b32 s41, s40, 4
  s_bfe_u32 s42, s40, 131074
  s_lshl_b32 s42, s42, 5
  s_bfe_u32 s88, s40, 65537
  s_add_u32 s42, s42, s88
  s_and_b32 s88, s40, 1
  s_lshl_b32 s88, s88, 4
  s_add_u32 s42, s42, s88
  v_and_b32 v9, 7, v1
  v_lshl_add_u32 v9, v9, 1, s42
  v_lshrrev_b32 v8, 4, v9
  v_lshlrev_b32 v8, 10, v8
  v_and_b32 v10, 15, v9
  v_lshl_add_u32 v8, v10, 4, v8
  v_lshlrev_b32 v9, 3, v9
  s_lshl_b32 s88, s41, 8
  s_add_u32 s89, s88, 45056
  s_add_u32 s88, s88, 20480
  s_lshl_b32 s43, s41, 10
  buffer_load_dwordx2 v[12:13], v9, s[48:51], s43 offen
  s_mov_b32 s90, 200000
L_poll_116:
  buffer_load_dwordx4 v[16:19], v8, s[44:47], s88 offen sc1
  buffer_load_dwordx4 v[20:23], v8, s[44:47], s89 offen sc1
  s_waitcnt vmcnt(0)
  v_cmp_ne_u64 vcc, s[84:85], v[18:19]
  v_cmp_ne_u64 s[92:93], s[84:85], v[22:23]
  s_or_b64 vcc, vcc, s[92:93]
  s_cbranch_vccz L_pdone_117
  s_sleep 16
  s_sub_u32 s90, s90, 1
  s_cmp_lg_u32 s90, 0
  s_cbranch_scc1 L_poll_116
L_pdone_117:
  v_and_b32 v9, 1, v3
  v_cmp_eq_u32 vcc, 1, v9
  s_nop 1
  v_cndmask_b32 v28, v12, v13, vcc
  v_cndmask_b32 v29, v16, v17, vcc
  v_cndmask_b32 v30, v20, v21, vcc
  v_lshrrev_b32 v9, 1, v3
  v_lshlrev_b32 v9, 4, v9
  v_lshrrev_b32 v28, v9, v28
  v_lshlrev_b32 v28, 16, v28
  v_lshrrev_b32 v29, v9, v29
  v_lshlrev_b32 v29, 16, v29
  v_lshrrev_b32 v30, v9, v30
  v_lshlrev_b32 v30, 16, v30
L_noRc:
  v_mov_b32 v15, 0
  v_mov_b32 v26, s84
  v_mov_b32 v27, s85
  s_lshl_b32 s89, s2, 4
  s_add_u32 s89, s89, 65536
  s_xor_b32 s89, s89, 512
  s_movk_i32 s94, 0x100
  s_mov_b64 exec, 1
  ds_read_b128 v[32:35], v15 offset:128
  ds_read_b64 v[24:25], v15 offset:144
  s_waitcnt lgkmcnt(0)
  s_mov_b32 s90, 200000
L_poll_118:
  buffer_load_dwordx4 v[36:39], v15, s[44:47], s89 offen sc1
  s_waitcnt vmcnt(0)
  v_cmp_ne_u64 vcc, s[84:85], v[38:39]
  s_cbranch_vccz L_pdone_119
  s_sleep 16
  s_sub_u32 s90, s90, 1
  s_cmp_lg_u32 s90, 0
  s_cbranch_scc1 L_poll_118
L_pdone_119:
  v_max_f32 v40, v24, v36
  v_sub_f32 v41, v24, v40
  v_sub_f32 v42, v36, v40
  v_exp_f32 v41, v41
  v_exp_f32 v42, v42
  v_mul_f32 v43, v41, v25
  v_fmac_f32 v43, v42, v37
  v_rcp_f32 v43, v43
  s_nop 0
  v_mul_f32 v41, v41, v43
  v_mul_f32 v32, v32, v41
  v_mul_f32 v33, v33, v41
  v_mul_f32 v34, v34, v41
  v_mul_f32 v35, v35, v41
  ds_write_b128 v15, v[32:35] offset:128
  s_mov_b64 exec, -1
L_noS:
  v_and_b32 v8, 3, v2
  v_mul_u32_u24 v8, 320, v8
  v_lshl_add_u32 v8, v3, 4, v8
  v_lshrrev_b32 v9, 3, v2
  v_mul_u32_u24 v9, 8320, v9
  v_and_b32 v10, 7, v2
  v_lshl_add_u32 v9, v10, 4, v9
  v_mov_b32 v10, 0
  v_mov_b32 v0, 0xfffff000
  s_mul_i32 s88, s30, 133120
  s_mul_i32 s95, s35, 33280
  s_add_u32 s88, s88, s95
  s_lshl_b32 s89, s34, 7
  s_add_u32 s88, s88, s89
  s_add_u32 s88, s88, 720896
  s_add_u32 s89, s88, 16640
  s_waitcnt lgkmcnt(0)
  s_barrier
  ds_read_b128 v[12:15], v8 offset:14336
  ds_read_b128 v[16:19], v8 offset:14400
  ds_read_b128 v[20:23], v8 offset:14464
  ds_read_b128 v[24:27], v8 offset:14528
  ds_read_b128 v[4:7], v10 offset:128
  s_waitcnt lgkmcnt(4)
  v_mfma_f32_16x16x32_bf16 v[32:35], v[12:15], v[64:67], 0
  v_mfma_f32_16x16x32_bf16 v[36:39], v[12:15], v[68:71], 0
  v_mfma_f32_16x16x32_bf16 v[40:43], v[12:15], v[72:75], 0
  v_mfma_f32_16x16x32_bf16 v[44:47], v[12:15], v[76:79], 0
  s_waitcnt lgkmcnt(3)
  v_mfma_f32_16x16x32_bf16 v[32:35], v[16:19], v[96:99], v[32:35]
  v_mfma_f32_16x16x32_bf16 v[36:39], v[16:19], v[100:103], v[36:39]
  v_mfma_f32_16x16x32_bf16 v[40:43], v[16:19], v[104:107], v[40:43]
  v_mfma_f32_16x16x32_bf16 v[44:47], v[16:19], v[108:111], v[44:47]
  s_waitcnt lgkmcnt(2)
  v_mfma_f32_16x16x32_bf16 v[32:35], v[20:23], v[128:131], v[32:35]
  v_mfma_f32_16x16x32_bf16 v[36:39], v[20:23], v[132:135], v[36:39]
  v_mfma_f32_16x16x32_bf16 v[40:43], v[20:23], v[136:139], v[40:43]
  v_mfma_f32_16x16x32_bf16 v[44:47], v[20:23], v[140:143], v[44:47]
  s_waitcnt lgkmcnt(1)
  v_mfma_f32_16x16x32_bf16 v[32:35], v[24:27], v[160:163], v[32:35]
  v_mfma_f32_16x16x32_bf16 v[36:39], v[24:27], v[164:167], v[36:39]
  v_mfma_f32_16x16x32_bf16 v[40:43], v[24:27], v[168:171], v[40:43]
  v_mfma_f32_16x16x32_bf16 v[44:47], v[24:27], v[172:175], v[44:47]
  s_waitcnt lgkmcnt(0)
  v_mfma_f32_16x16x32_bf16 v[48:51], v[12:15], v[80:83], 0
  v_mfma_f32_16x16x32_bf16 v[52:55], v[12:15], v[84:87], 0
  v_mfma_f32_16x16x32_bf16 v[56:59], v[12:15], v[88:91], 0
  v_mfma_f32_16x16x32_bf16 v[60:63], v[12:15], v[92:95], 0
  v_mfma_f32_16x16x32_bf16 v[48:51], v[16:19], v[112:115], v[48:51]
  v_mul_f32 v64, v4, v32
  v_mul_f32 v65, v4, v36
  v_mfma_f32_16x16x32_bf16 v[52:55], v[16:19], v[116:119], v[52:55]
  v_mul_f32 v66, v4, v40
  v_mul_f32 v67, v4, v44
  v_mfma_f32_16x16x32_bf16 v[56:59], v[16:19], v[120:123], v[56:59]
  v_fmac_f32 v64, v5, v33
  v_fmac_f32 v65, v5, v37
  v_mfma_f32_16x16x32_bf16 v[60:63], v[16:19], v[124:127], v[60:63]
  v_fmac_f32 v66, v5, v41
  v_fmac_f32 v67, v5, v45
  v_mfma_f32_16x16x32_bf16 v[48:51], v[20:23], v[144:147], v[48:51]
  v_fmac_f32 v64, v6, v34
  v_fmac_f32 v65, v6, v38
  v_mfma_f32_16x16x32_bf16 v[52:55], v[20:23], v[148:151], v[52:55]
  v_fmac_f32 v66, v6, v42
  v_fmac_f32 v67, v6, v46
  v_mfma_f32_16x16x32_bf16 v[56:59], v[20:23], v[152:155], v[56:59]
  v_fmac_f32 v64, v7, v35
  v_fmac_f32 v65, v7, v39
  v_mfma_f32_16x16x32_bf16 v[60:63], v[20:23], v[156:159], v[60:63]
  v_fmac_f32 v66, v7, v43
  v_fmac_f32 v67, v7, v47
  v_mfma_f32_16x16x32_bf16 v[48:51], v[24:27], v[176:179], v[48:51]
  v_add_u32 v64, 0x800, v64
  v_add_u32 v65, 0x800, v65
  v_mfma_f32_16x16x32_bf16 v[52:55], v[24:27], v[180:183], v[52:55]
  v_add_u32 v66, 0x800, v66
  v_add_u32 v67, 0x800, v67
  v_mfma_f32_16x16x32_bf16 v[56:59], v[24:27], v[184:187], v[56:59]
  v_and_or_b32 v64, v64, v0, s12
  v_and_or_b32 v65, v65, v0, s13
  v_mfma_f32_16x16x32_bf16 v[60:63], v[24:27], v[188:191], v[60:63]
  v_and_or_b32 v66, v66, v0, s14
  v_and_or_b32 v67, v67, v0, s15
  s_mov_b64 exec, 0xffff
  buffer_store_dwordx4 v[64:67], v9, s[44:47], s88 offen sc1
  v_mul_f32 v68, v4, v48
  v_mul_f32 v69, v4, v52
  v_mul_f32 v70, v4, v56
  s_nop 0
  v_mul_f32 v71, v4, v60
  v_fmac_f32 v68, v5, v49
  v_fmac_f32 v69, v5, v53
  v_fmac_f32 v70, v5, v57
  v_fmac_f32 v71, v5, v61
  v_fmac_f32 v68, v6, v50
  v_fmac_f32 v69, v6, v54
  v_fmac_f32 v70, v6, v58
  v_fmac_f32 v71, v6, v62
  v_fmac_f32 v68, v7, v51
  v_fmac_f32 v69, v7, v55
  v_fmac_f32 v70, v7, v59
  v_fmac_f32 v71, v7, v63
  v_add_u32 v68, 0x800, v68
  v_add_u32 v69, 0x800, v69
  v_add_u32 v70, 0x800, v70
  v_add_u32 v71, 0x800, v71
  v_and_or_b32 v68, v68, v0, s12
  v_and_or_b32 v69, v69, v0, s13
  v_and_or_b32 v70, v70, v0, s14
  v_and_or_b32 v71, v71, v0, s15
  buffer_store_dwordx4 v[68:71], v9, s[44:47], s89 offen sc1
  s_mov_b64 exec, -1
  v_lshlrev_b32 v7, 4, v1
  v_lshlrev_b32 v5, 3, v1
  v_lshrrev_b32 v6, 2, v2
  s_cmp_ge_u32 s40, 64
  s_cbranch_scc1 L_noR1
  s_cmp_lg_u32 s35, 0
  s_cbranch_scc1 L_fin
  s_mul_i32 s88, s40, 8320
  s_add_u32 s38, s88, 1310720
  s_add_u32 s39, s38, 4096
  s_add_u32 s88, s88, 720896
  s_add_u32 s89, s88, 4096
  s_lshl_b32 s94, s40, 7
  s_add_u32 s94, s94, 294912
  v_lshrrev_b32 v4, 3, v1
  v_mul_u32_u24 v4, 8320, v4
  v_and_b32 v8, 7, v1
  v_lshl_add_u32 v4, v8, 4, v4
  v_lshl_add_u32 v8, v8, 1, s42
  v_lshlrev_b32 v8, 3, v8
  s_mov_b32 s90, 200000
  buffer_load_dwordx4 v[128:131], v7, s[44:47], s88 offen offset:0 sc1
  buffer_load_dwordx4 v[132:135], v7, s[44:47], s88 offen offset:1024 sc1
  buffer_load_dwordx4 v[136:139], v7, s[44:47], s88 offen offset:2048 sc1
  buffer_load_dwordx4 v[140:143], v7, s[44:47], s88 offen offset:3072 sc1
  buffer_load_dwordx4 v[144:147], v7, s[44:47], s89 offen offset:0 sc1
  buffer_load_dwordx4 v[148:151], v7, s[44:47], s89 offen offset:1024 sc1
  buffer_load_dwordx4 v[152:155], v7, s[44:47], s89 offen offset:2048 sc1
  buffer_load_dwordx4 v[156:159], v7, s[44:47], s89 offen offset:3072 sc1
L_pk_120:
  buffer_load_dwordx4 v[160:163], v7, s[44:47], s88 offen offset:0 sc1
  buffer_load_dwordx4 v[164:167], v7, s[44:47], s88 offen offset:1024 sc1
  buffer_load_dwordx4 v[168:171], v7, s[44:47], s88 offen offset:2048 sc1
  buffer_load_dwordx4 v[172:175], v7, s[44:47], s88 offen offset:3072 sc1
  buffer_load_dwordx4 v[176:179], v7, s[44:47], s89 offen offset:0 sc1
  buffer_load_dwordx4 v[180:183], v7, s[44:47], s89 offen offset:1024 sc1
  buffer_load_dwordx4 v[184:187], v7, s[44:47], s89 offen offset:2048 sc1
  buffer_load_dwordx4 v[188:191], v7, s[44:47], s89 offen offset:3072 sc1
  s_waitcnt vmcnt(15)
  v_xor_b32 v80, s12, v128
  v_xor_b32 v81, s13, v129
  v_xor_b32 v82, s14, v130
  v_xor_b32 v83, s15, v131
  v_or_b32 v12, v80, v81
  v_or_b32 v13, v82, v83
  s_waitcnt vmcnt(14)
  v_xor_b32 v88, s12, v132
  v_xor_b32 v89, s13, v133
  v_xor_b32 v90, s14, v134
  v_xor_b32 v91, s15, v135
  v_or3_b32 v12, v12, v88, v89
  v_or3_b32 v13, v13, v90, v91
  v_pk_add_f32 v[80:81], v[80:81], v[88:89]
  v_pk_add_f32 v[82:83], v[82:83], v[90:91]
  s_waitcnt vmcnt(13)
  v_xor_b32 v84, s12, v136
  v_xor_b32 v85, s13, v137
  v_xor_b32 v86, s14, v138
  v_xor_b32 v87, s15, v139
  v_or3_b32 v12, v12, v84, v85
  v_or3_b32 v13, v13, v86, v87
  v_pk_add_f32 v[80:81], v[80:81], v[84:85]
  v_pk_add_f32 v[82:83], v[82:83], v[86:87]
  s_waitcnt vmcnt(12)
  v_xor_b32 v88, s12, v140
  v_xor_b32 v89, s13, v141
  v_xor_b32 v90, s14, v142
  v_xor_b32 v91, s15, v143
  v_or3_b32 v12, v12, v88, v89
  v_or3_b32 v13, v13, v90, v91
  v_pk_add_f32 v[80:81], v[80:81], v[88:89]
  v_pk_add_f32 v[82:83], v[82:83], v[90:91]
  s_waitcnt vmcnt(11)
  v_xor_b32 v84, s12, v144
  v_xor_b32 v85, s13, v145
  v_xor_b32 v86, s14, v146
  v_xor_b32 v87, s15, v147
  v_or3_b32 v12, v12, v84, v85
  v_or3_b32 v13, v13, v86, v87
  v_pk_add_f32 v[80:81], v[80:81], v[84:85]
  v_pk_add_f32 v[82:83], v[82:83], v[86:87]
  s_waitcnt vmcnt(10)
  v_xor_b32 v88, s12, v148
  v_xor_b32 v89, s13, v149
  v_xor_b32 v90, s14, v150
  v_xor_b32 v91, s15, v151
  v_or3_b32 v12, v12, v88, v89
  v_or3_b32 v13, v13, v90, v91
  v_pk_add_f32 v[80:81], v[80:81], v[88:89]
  v_pk_add_f32 v[82:83], v[82:83], v[90:91]
  s_waitcnt vmcnt(9)
  v_xor_b32 v84, s12, v152
  v_xor_b32 v85, s13, v153
  v_xor_b32 v86, s14, v154
  v_xor_b32 v87, s15, v155
  v_or3_b32 v12, v12, v84, v85
  v_or3_b32 v13, v13, v86, v87
  v_pk_add_f32 v[80:81], v[80:81], v[84:85]
  v_pk_add_f32 v[82:83], v[82:83], v[86:87]
  s_waitcnt vmcnt(8)
  v_xor_b32 v88, s12, v156
  v_xor_b32 v89, s13, v157
  v_xor_b32 v90, s14, v158
  v_xor_b32 v91, s15, v159
  v_or3_b32 v12, v12, v88, v89
  v_or3_b32 v13, v13, v90, v91
  v_pk_add_f32 v[80:81], v[80:81], v[88:89]
  v_pk_add_f32 v[82:83], v[82:83], v[90:91]
  v_or_b32 v12, v12, v13
  v_and_b32 v12, 0xfff, v12
  v_cmp_ne_u32 vcc, 0, v12
  s_cbranch_vccz L_pkd_121
  buffer_load_dwordx4 v[128:131], v7, s[44:47], s88 offen offset:0 sc1
  buffer_load_dwordx4 v[132:135], v7, s[44:47], s88 offen offset:1024 sc1
  buffer_load_dwordx4 v[136:139], v7, s[44:47], s88 offen offset:2048 sc1
  buffer_load_dwordx4 v[140:143], v7, s[44:47], s88 offen offset:3072 sc1
  buffer_load_dwordx4 v[144:147], v7, s[44:47], s89 offen offset:0 sc1
  buffer_load_dwordx4 v[148:151], v7, s[44:47], s89 offen offset:1024 sc1
  buffer_load_dwordx4 v[152:155], v7, s[44:47], s89 offen offset:2048 sc1
  buffer_load_dwordx4 v[156:159], v7, s[44:47], s89 offen offset:3072 sc1
  s_waitcnt vmcnt(15)
  v_xor_b32 v80, s12, v160
  v_xor_b32 v81, s13, v161
  v_xor_b32 v82, s14, v162
  v_xor_b32 v83, s15, v163
  v_or_b32 v12, v80, v81
  v_or_b32 v13, v82, v83
  s_waitcnt vmcnt(14)
  v_xor_b32 v88, s12, v164
  v_xor_b32 v89, s13, v165
  v_xor_b32 v90, s14, v166
  v_xor_b32 v91, s15, v167
  v_or3_b32 v12, v12, v88, v89
  v_or3_b32 v13, v13, v90, v91
  v_pk_add_f32 v[80:81], v[80:81], v[88:89]
  v_pk_add_f32 v[82:83], v[82:83], v[90:91]
  s_waitcnt vmcnt(13)
  v_xor_b32 v84, s12, v168
  v_xor_b32 v85, s13, v169
  v_xor_b32 v86, s14, v170
  v_xor_b32 v87, s15, v171
  v_or3_b32 v12, v12, v84, v85
  v_or3_b32 v13, v13, v86, v87
  v_pk_add_f32 v[80:81], v[80:81], v[84:85]
  v_pk_add_f32 v[82:83], v[82:83], v[86:87]
  s_waitcnt vmcnt(12)
  v_xor_b32 v88, s12, v172
  v_xor_b32 v89, s13, v173
  v_xor_b32 v90, s14, v174
  v_xor_b32 v91, s15, v175
  v_or3_b32 v12, v12, v88, v89
  v_or3_b32 v13, v13, v90, v91
  v_pk_add_f32 v[80:81], v[80:81], v[88:89]
  v_pk_add_f32 v[82:83], v[82:83], v[90:91]
  s_waitcnt vmcnt(11)
  v_xor_b32 v84, s12, v176
  v_xor_b32 v85, s13, v177
  v_xor_b32 v86, s14, v178
  v_xor_b32 v87, s15, v179
  v_or3_b32 v12, v12, v84, v85
  v_or3_b32 v13, v13, v86, v87
  v_pk_add_f32 v[80:81], v[80:81], v[84:85]
  v_pk_add_f32 v[82:83], v[82:83], v[86:87]
  s_waitcnt vmcnt(10)
  v_xor_b32 v88, s12, v180
  v_xor_b32 v89, s13, v181
  v_xor_b32 v90, s14, v182
  v_xor_b32 v91, s15, v183
  v_or3_b32 v12, v12, v88, v89
  v_or3_b32 v13, v13, v90, v91
  v_pk_add_f32 v[80:81], v[80:81], v[88:89]
  v_pk_add_f32 v[82:83], v[82:83], v[90:91]
  s_waitcnt vmcnt(9)
  v_xor_b32 v84, s12, v184
  v_xor_b32 v85, s13, v185
  v_xor_b32 v86, s14, v186
  v_xor_b32 v87, s15, v187
  v_or3_b32 v12, v12, v84, v85
  v_or3_b32 v13, v13, v86, v87
  v_pk_add_f32 v[80:81], v[80:81], v[84:85]
  v_pk_add_f32 v[82:83], v[82:83], v[86:87]
  s_waitcnt vmcnt(8)
  v_xor_b32 v88, s12, v188
  v_xor_b32 v89, s13, v189
  v_xor_b32 v90, s14, v190
  v_xor_b32 v91, s15, v191
  v_or3_b32 v12, v12, v88, v89
  v_or3_b32 v13, v13, v90, v91
  v_pk_add_f32 v[80:81], v[80:81], v[88:89]
  v_pk_add_f32 v[82:83], v[82:83], v[90:91]
  v_or_b32 v12, v12, v13
  v_and_b32 v12, 0xfff, v12
  v_cmp_ne_u32 vcc, 0, v12
  s_cbranch_vccz L_pkd_121
  s_sub_u32 s90, s90, 1
  s_cmp_lg_u32 s90, 0
  s_cbranch_scc1 L_pk_120
L_pkd_121:
  v_permlane32_swap_b32 v80, v81
  v_permlane32_swap_b32 v82, v83
  v_add_f32 v80, v80, v81
  v_add_f32 v82, v82, v83
  s_nop 1
  v_permlane16_swap_b32 v80, v82
  v_add_f32 v80, v80, v82
  s_nop 1
  v_add_f32_dpp v80, v80, v80 row_ror:8 row_mask:0xf bank_mask:0xf
  v_cvt_pk_bf16_f32 v80, 0, v80
  v_mul_f32 v80, v80, v29
  v_cvt_pk_bf16_f32 v80, 0, v80
  v_add_f32 v28, v28, v80
  v_cvt_pk_bf16_f32 v28, 0, v28
  v_mov_b32 v80, v28
  v_mov_b32 v81, v28
  s_nop 1
  v_permlane32_swap_b32 v80, v81
  v_perm_b32 v80, v81, v80, s87
  v_mov_b32 v81, v80
  s_nop 1
  v_permlane16_swap_b32 v80, v81
  s_mov_b32 exec_lo, 0xffffffff
  s_mov_b32 exec_hi, 0xffffffff
  v_mov_b32 v82, s84
  v_mov_b32 v83, s85
  buffer_store_dwordx4 v[80:83], v4, s[44:47], s94 offen sc1
  s_mov_b64 exec, -1
  s_mov_b32 s90, 200000
  buffer_load_dwordx4 v[192:195], v7, s[44:47], s38 offen offset:0 sc1
  buffer_load_dwordx4 v[196:199], v7, s[44:47], s38 offen offset:1024 sc1
  buffer_load_dwordx4 v[200:203], v7, s[44:47], s38 offen offset:2048 sc1
  buffer_load_dwordx4 v[204:207], v7, s[44:47], s38 offen offset:3072 sc1
  buffer_load_dwordx4 v[208:211], v7, s[44:47], s39 offen offset:0 sc1
  buffer_load_dwordx4 v[212:215], v7, s[44:47], s39 offen offset:1024 sc1
  buffer_load_dwordx4 v[216:219], v7, s[44:47], s39 offen offset:2048 sc1
L_pk_122:
  buffer_load_dwordx4 v[224:227], v7, s[44:47], s38 offen offset:0 sc1
  buffer_load_dwordx4 v[228:231], v7, s[44:47], s38 offen offset:1024 sc1
  buffer_load_dwordx4 v[232:235], v7, s[44:47], s38 offen offset:2048 sc1
  buffer_load_dwordx4 v[236:239], v7, s[44:47], s38 offen offset:3072 sc1
  buffer_load_dwordx4 v[240:243], v7, s[44:47], s39 offen offset:0 sc1
  buffer_load_dwordx4 v[244:247], v7, s[44:47], s39 offen offset:1024 sc1
  buffer_load_dwordx4 v[248:251], v7, s[44:47], s39 offen offset:2048 sc1
  s_waitcnt vmcnt(13)
  v_xor_b32 v80, s12, v192
  v_xor_b32 v81, s13, v193
  v_xor_b32 v82, s14, v194
  v_xor_b32 v83, s15, v195
  v_or_b32 v12, v80, v81
  v_or_b32 v13, v82, v83
  s_waitcnt vmcnt(12)
  v_xor_b32 v88, s12, v196
  v_xor_b32 v89, s13, v197
  v_xor_b32 v90, s14, v198
  v_xor_b32 v91, s15, v199
  v_or3_b32 v12, v12, v88, v89
  v_or3_b32 v13, v13, v90, v91
  v_pk_add_f32 v[80:81], v[80:81], v[88:89]
  v_pk_add_f32 v[82:83], v[82:83], v[90:91]
  s_waitcnt vmcnt(11)
  v_xor_b32 v84, s12, v200
  v_xor_b32 v85, s13, v201
  v_xor_b32 v86, s14, v202
  v_xor_b32 v87, s15, v203
  v_or3_b32 v12, v12, v84, v85
  v_or3_b32 v13, v13, v86, v87
  v_pk_add_f32 v[80:81], v[80:81], v[84:85]
  v_pk_add_f32 v[82:83], v[82:83], v[86:87]
  s_waitcnt vmcnt(10)
  v_xor_b32 v88, s12, v204
  v_xor_b32 v89, s13, v205
  v_xor_b32 v90, s14, v206
  v_xor_b32 v91, s15, v207
  v_or3_b32 v12, v12, v88, v89
  v_or3_b32 v13, v13, v90, v91
  v_pk_add_f32 v[80:81], v[80:81], v[88:89]
  v_pk_add_f32 v[82:83], v[82:83], v[90:91]
  s_waitcnt vmcnt(9)
  v_xor_b32 v84, s12, v208
  v_xor_b32 v85, s13, v209
  v_xor_b32 v86, s14, v210
  v_xor_b32 v87, s15, v211
  v_or3_b32 v12, v12, v84, v85
  v_or3_b32 v13, v13, v86, v87
  v_pk_add_f32 v[80:81], v[80:81], v[84:85]
  v_pk_add_f32 v[82:83], v[82:83], v[86:87]
  s_waitcnt vmcnt(8)
  v_xor_b32 v88, s12, v212
  v_xor_b32 v89, s13, v213
  v_xor_b32 v90, s14, v214
  v_xor_b32 v91, s15, v215
  v_or3_b32 v12, v12, v88, v89
  v_or3_b32 v13, v13, v90, v91
  v_pk_add_f32 v[80:81], v[80:81], v[88:89]
  v_pk_add_f32 v[82:83], v[82:83], v[90:91]
  s_waitcnt vmcnt(7)
  v_xor_b32 v84, s12, v216
  v_xor_b32 v85, s13, v217
  v_xor_b32 v86, s14, v218
  v_xor_b32 v87, s15, v219
  v_or3_b32 v12, v12, v84, v85
  v_or3_b32 v13, v13, v86, v87
  v_pk_add_f32 v[80:81], v[80:81], v[84:85]
  v_pk_add_f32 v[82:83], v[82:83], v[86:87]
  v_or_b32 v12, v12, v13
  v_and_b32 v12, 0xfff, v12
  v_cmp_ne_u32 vcc, 0, v12
  s_cbranch_vccz L_pkd_123
  buffer_load_dwordx4 v[192:195], v7, s[44:47], s38 offen offset:0 sc1
  buffer_load_dwordx4 v[196:199], v7, s[44:47], s38 offen offset:1024 sc1
  buffer_load_dwordx4 v[200:203], v7, s[44:47], s38 offen offset:2048 sc1
  buffer_load_dwordx4 v[204:207], v7, s[44:47], s38 offen offset:3072 sc1
  buffer_load_dwordx4 v[208:211], v7, s[44:47], s39 offen offset:0 sc1
  buffer_load_dwordx4 v[212:215], v7, s[44:47], s39 offen offset:1024 sc1
  buffer_load_dwordx4 v[216:219], v7, s[44:47], s39 offen offset:2048 sc1
  s_waitcnt vmcnt(13)
  v_xor_b32 v80, s12, v224
  v_xor_b32 v81, s13, v225
  v_xor_b32 v82, s14, v226
  v_xor_b32 v83, s15, v227
  v_or_b32 v12, v80, v81
  v_or_b32 v13, v82, v83
  s_waitcnt vmcnt(12)
  v_xor_b32 v88, s12, v228
  v_xor_b32 v89, s13, v229
  v_xor_b32 v90, s14, v230
  v_xor_b32 v91, s15, v231
  v_or3_b32 v12, v12, v88, v89
  v_or3_b32 v13, v13, v90, v91
  v_pk_add_f32 v[80:81], v[80:81], v[88:89]
  v_pk_add_f32 v[82:83], v[82:83], v[90:91]
  s_waitcnt vmcnt(11)
  v_xor_b32 v84, s12, v232
  v_xor_b32 v85, s13, v233
  v_xor_b32 v86, s14, v234
  v_xor_b32 v87, s15, v235
  v_or3_b32 v12, v12, v84, v85
  v_or3_b32 v13, v13, v86, v87
  v_pk_add_f32 v[80:81], v[80:81], v[84:85]
  v_pk_add_f32 v[82:83], v[82:83], v[86:87]
  s_waitcnt vmcnt(10)
  v_xor_b32 v88, s12, v236
  v_xor_b32 v89, s13, v237
  v_xor_b32 v90, s14, v238
  v_xor_b32 v91, s15, v239
  v_or3_b32 v12, v12, v88, v89
  v_or3_b32 v13, v13, v90, v91
  v_pk_add_f32 v[80:81], v[80:81], v[88:89]
  v_pk_add_f32 v[82:83], v[82:83], v[90:91]
  s_waitcnt vmcnt(9)
  v_xor_b32 v84, s12, v240
  v_xor_b32 v85, s13, v241
  v_xor_b32 v86, s14, v242
  v_xor_b32 v87, s15, v243
  v_or3_b32 v12, v12, v84, v85
  v_or3_b32 v13, v13, v86, v87
  v_pk_add_f32 v[80:81], v[80:81], v[84:85]
  v_pk_add_f32 v[82:83], v[82:83], v[86:87]
  s_waitcnt vmcnt(8)
  v_xor_b32 v88, s12, v244
  v_xor_b32 v89, s13, v245
  v_xor_b32 v90, s14, v246
  v_xor_b32 v91, s15, v247
  v_or3_b32 v12, v12, v88, v89
  v_or3_b32 v13, v13, v90, v91
  v_pk_add_f32 v[80:81], v[80:81], v[88:89]
  v_pk_add_f32 v[82:83], v[82:83], v[90:91]
  s_waitcnt vmcnt(7)
  v_xor_b32 v84, s12, v248
  v_xor_b32 v85, s13, v249
  v_xor_b32 v86, s14, v250
  v_xor_b32 v87, s15, v251
  v_or3_b32 v12, v12, v84, v85
  v_or3_b32 v13, v13, v86, v87
  v_pk_add_f32 v[80:81], v[80:81], v[84:85]
  v_pk_add_f32 v[82:83], v[82:83], v[86:87]
  v_or_b32 v12, v12, v13
  v_and_b32 v12, 0xfff, v12
  v_cmp_ne_u32 vcc, 0, v12
  s_cbranch_vccz L_pkd_123
  s_sub_u32 s90, s90, 1
  s_cmp_lg_u32 s90, 0
  s_cbranch_scc1 L_pk_122
L_pkd_123:
  v_permlane32_swap_b32 v80, v81
  v_permlane32_swap_b32 v82, v83
  v_add_f32 v80, v80, v81
  v_add_f32 v82, v82, v83
  s_nop 1
  v_permlane16_swap_b32 v80, v82
  v_add_f32 v80, v80, v82
  s_nop 1
  v_add_f32_dpp v80, v80, v80 row_ror:8 row_mask:0xf bank_mask:0xf
  v_cvt_pk_bf16_f32 v80, 0, v80
  v_mul_f32 v80, v80, v30
  v_cvt_pk_bf16_f32 v80, 0, v80
  v_add_f32 v28, v28, v80
  v_cvt_pk_bf16_f32 v28, 0, v28
  v_mov_b32 v80, v28
  v_mov_b32 v81, v28
  s_nop 1
  v_permlane32_swap_b32 v80, v81
  v_perm_b32 v80, v81, v80, s87
  v_mov_b32 v81, v80
  s_nop 1
  v_permlane16_swap_b32 v80, v81
  s_mov_b64 exec, 255
  buffer_store_dwordx2 v[80:81], v8, s[76:79], s43 offen sc1
  s_cmp_lg_u32 s40, 0
  s_cbranch_scc1 L_fin
  s_mov_b64 exec, 1
  v_mov_b32 v82, s84
  v_mov_b32 v83, s85
  buffer_store_dwordx2 v[82:83], v10, s[44:47], 0 offen
  s_branch L_fin
L_noR1:
  s_cmp_ge_u32 s36, 56
  s_cbranch_scc1 L_fin
  ds_read_b128 v[96:99], v11 offset:16384
  ds_read_b128 v[100:103], v11 offset:17408
  ds_read_b128 v[104:107], v11 offset:18432
  ds_read_b128 v[108:111], v11 offset:19456
  s_and_b32 s88, s2, 7
  s_mul_i32 s88, s88, 8320
  s_lshl_b32 s89, s35, 11
  s_add_u32 s88, s88, s89
  s_add_u32 s88, s88, 294912
  s_mul_i32 s89, s35, 1088
  s_add_u32 s89, s89, 6144
  v_lshrrev_b32 v10, 1, v3
  v_lshl_add_u32 v8, v10, 8, s89
  v_lshl_add_u32 v8, v2, 4, v8
  v_and_b32 v10, 1, v3
  v_lshl_add_u32 v8, v10, 3, v8
  v_mul_u32_u24 v19, 1088, v6
  v_lshl_add_u32 v19, v3, 4, v19
  s_lshl_b32 s89, s35, 8
  v_add_u32 v19, s89, v19
  v_and_b32 v16, 3, v2
  v_lshl_add_u32 v16, v3, 2, v16
  v_lshl_add_u32 v16, v6, 4, v16
  v_lshlrev_b32 v16, 3, v16
  s_lshl_b32 s89, s35, 9
  v_add_u32 v10, s89, v5
  v_mul_u32_u24 v18, 133120, v3
  v_add_u32 v18, v18, v9
  s_lshl_b32 s89, s36, 7
  s_add_u32 s94, s95, s89
  s_add_u32 s94, s94, 1310720
  s_add_u32 s95, s94, 16640
  s_waitcnt lgkmcnt(0)
  s_mov_b32 s90, 200000
  buffer_load_dwordx4 v[160:163], v7, s[44:47], s88 offen sc1
  buffer_load_dwordx4 v[164:167], v7, s[44:47], s88 offen offset:1024 sc1
L_pk_124:
  buffer_load_dwordx4 v[168:171], v7, s[44:47], s88 offen sc1
  buffer_load_dwordx4 v[172:175], v7, s[44:47], s88 offen offset:1024 sc1
  s_waitcnt vmcnt(2)
  v_cmp_ne_u64 vcc, s[84:85], v[162:163]
  v_cmp_ne_u64 s[92:93], s[84:85], v[166:167]
  s_or_b64 vcc, vcc, s[92:93]
  v_lshlrev_b32 v116, 16, v160
  v_and_b32 v117, 0xffff0000, v160
  v_lshlrev_b32 v118, 16, v161
  v_and_b32 v119, 0xffff0000, v161
  v_lshlrev_b32 v120, 16, v164
  v_and_b32 v121, 0xffff0000, v164
  v_lshlrev_b32 v122, 16, v165
  v_and_b32 v123, 0xffff0000, v165
  s_cbranch_vccz L_pkd_125
  buffer_load_dwordx4 v[160:163], v7, s[44:47], s88 offen sc1
  buffer_load_dwordx4 v[164:167], v7, s[44:47], s88 offen offset:1024 sc1
  s_waitcnt vmcnt(2)
  v_cmp_ne_u64 vcc, s[84:85], v[170:171]
  v_cmp_ne_u64 s[92:93], s[84:85], v[174:175]
  s_or_b64 vcc, vcc, s[92:93]
  v_lshlrev_b32 v116, 16, v168
  v_and_b32 v117, 0xffff0000, v168
  v_lshlrev_b32 v118, 16, v169
  v_and_b32 v119, 0xffff0000, v169
  v_lshlrev_b32 v120, 16, v172
  v_and_b32 v121, 0xffff0000, v172
  v_lshlrev_b32 v122, 16, v173
  v_and_b32 v123, 0xffff0000, v173
  s_cbranch_vccz L_pkd_125
  s_sub_u32 s90, s90, 1
  s_cmp_lg_u32 s90, 0
  s_cbranch_scc1 L_pk_124
L_pkd_125:
  v_pk_add_f32 v[12:13], v[116:117], v[118:119]
  v_pk_add_f32 v[14:15], v[120:121], v[122:123]
  v_pk_add_f32 v[12:13], v[12:13], v[14:15]
  v_add_f32 v12, v12, v13
  s_nop 1
  v_add_f32_dpp v12, v12, v12 row_ror:8 row_mask:0xf bank_mask:0xf
  s_nop 1
  v_add_f32_dpp v12, v12, v12 row_ror:4 row_mask:0xf bank_mask:0xf
  s_nop 1
  v_add_f32_dpp v12, v12, v12 row_ror:2 row_mask:0xf bank_mask:0xf
  s_nop 1
  v_add_f32_dpp v12, v12, v12 row_ror:1 row_mask:0xf bank_mask:0xf
  v_mov_b32 v13, v12
  s_nop 1
  v_permlane16_swap_b32 v12, v13
  v_add_f32 v12, v12, v13
  v_mov_b32 v13, v12
  s_nop 1
  v_permlane32_swap_b32 v12, v13
  v_add_f32 v12, v12, v13
  v_mul_f32 v12, 0x3b000000, v12
  v_sub_f32 v124, v116, v12
  v_sub_f32 v125, v117, v12
  v_sub_f32 v126, v118, v12
  v_sub_f32 v127, v119, v12
  v_sub_f32 v128, v120, v12
  v_sub_f32 v129, v121, v12
  v_sub_f32 v130, v122, v12
  v_sub_f32 v131, v123, v12
  v_mul_f32 v13, v124, v124
  v_mul_f32 v14, v125, v125
  v_fmac_f32 v13, v126, v126
  v_fmac_f32 v14, v127, v127
  v_fmac_f32 v13, v128, v128
  v_fmac_f32 v14, v129, v129
  v_fmac_f32 v13, v130, v130
  v_fmac_f32 v14, v131, v131
  v_add_f32 v13, v13, v14
  v_cvt_pk_bf16_f32 v12, 0, v12
  v_sub_f32 v116, v116, v12
  v_sub_f32 v117, v117, v12
  v_add_f32_dpp v13, v13, v13 row_ror:8 row_mask:0xf bank_mask:0xf
  v_sub_f32 v118, v118, v12
  v_sub_f32 v119, v119, v12
  v_add_f32_dpp v13, v13, v13 row_ror:4 row_mask:0xf bank_mask:0xf
  v_sub_f32 v120, v120, v12
  v_sub_f32 v121, v121, v12
  v_add_f32_dpp v13, v13, v13 row_ror:2 row_mask:0xf bank_mask:0xf
  v_sub_f32 v122, v122, v12
  v_sub_f32 v123, v123, v12
  v_add_f32_dpp v13, v13, v13 row_ror:1 row_mask:0xf bank_mask:0xf
  v_mov_b32 v14, v13
  v_cvt_pk_bf16_f32 v116, 0, v116
  v_cvt_pk_bf16_f32 v117, 0, v117
  v_permlane16_swap_b32 v13, v14
  v_add_f32 v13, v13, v14
  v_mov_b32 v14, v13
  v_cvt_pk_bf16_f32 v118, 0, v118
  v_cvt_pk_bf16_f32 v119, 0, v119
  v_permlane32_swap_b32 v13, v14
  v_add_f32 v13, v13, v14
  v_mul_f32 v13, 0x3b000000, v13
  v_cvt_pk_bf16_f32 v13, 0, v13
  v_add_f32 v13, 0x3727c5ac, v13
  v_cvt_pk_bf16_f32 v13, 0, v13
  v_sqrt_f32 v13, v13
  v_cvt_pk_bf16_f32 v120, 0, v120
  v_cvt_pk_bf16_f32 v13, 0, v13
  v_rcp_f32 v13, v13
  v_cvt_pk_bf16_f32 v121, 0, v121
  v_cvt_pk_bf16_f32 v122, 0, v122
  v_cvt_pk_bf16_f32 v123, 0, v123
  v_mul_f32 v116, v116, v13
  v_mul_f32 v117, v117, v13
  v_mul_f32 v118, v118, v13
  v_mul_f32 v119, v119, v13
  v_mul_f32 v120, v120, v13
  v_mul_f32 v121, v121, v13
  v_mul_f32 v122, v122, v13
  v_mul_f32 v123, v123, v13
  v_cvt_pk_bf16_f32 v116, 0, v116
  v_cvt_pk_bf16_f32 v117, 0, v117
  v_cvt_pk_bf16_f32 v118, 0, v118
  v_cvt_pk_bf16_f32 v119, 0, v119
  v_cvt_pk_bf16_f32 v120, 0, v120
  v_cvt_pk_bf16_f32 v121, 0, v121
  v_cvt_pk_bf16_f32 v122, 0, v122
  v_cvt_pk_bf16_f32 v123, 0, v123
  v_pk_mul_f32 v[116:117], v[116:117], v[104:105]
  v_pk_mul_f32 v[118:119], v[118:119], v[106:107]
  v_pk_mul_f32 v[120:121], v[120:121], v[108:109]
  v_pk_mul_f32 v[122:123], v[122:123], v[110:111]
  v_cvt_pk_bf16_f32 v116, 0, v116
  v_cvt_pk_bf16_f32 v117, 0, v117
  v_cvt_pk_bf16_f32 v118, 0, v118
  v_cvt_pk_bf16_f32 v119, 0, v119
  v_cvt_pk_bf16_f32 v120, 0, v120
  v_cvt_pk_bf16_f32 v121, 0, v121
  v_cvt_pk_bf16_f32 v122, 0, v122
  v_cvt_pk_bf16_f32 v123, 0, v123
  v_pk_add_f32 v[116:117], v[116:117], v[96:97]
  v_pk_add_f32 v[118:119], v[118:119], v[98:99]
  v_pk_add_f32 v[120:121], v[120:121], v[100:101]
  v_pk_add_f32 v[122:123], v[122:123], v[102:103]
  v_cvt_pk_bf16_f32 v112, v116, v117
  v_cvt_pk_bf16_f32 v113, v118, v119
  v_cvt_pk_bf16_f32 v114, v120, v121
  v_cvt_pk_bf16_f32 v115, v122, v123
  ds_write2_b64 v8, v[112:113], v[114:115] offset0:0 offset1:64
  s_waitcnt lgkmcnt(0)
  s_barrier
  ds_read_b128 v[128:131], v19 offset:6144
  ds_read_b128 v[132:135], v19 offset:6208
  ds_read_b128 v[136:139], v19 offset:6272
  ds_read_b128 v[140:143], v19 offset:6336
  s_waitcnt lgkmcnt(3)
  v_mfma_f32_16x16x32_bf16 v[32:35], v[128:131], v[192:195], 0
  v_mfma_f32_16x16x32_bf16 v[36:39], v[128:131], v[196:199], 0
  s_waitcnt lgkmcnt(2)
  v_mfma_f32_16x16x32_bf16 v[32:35], v[132:135], v[200:203], v[32:35]
  v_mfma_f32_16x16x32_bf16 v[36:39], v[132:135], v[204:207], v[36:39]
  s_waitcnt lgkmcnt(1)
  v_mfma_f32_16x16x32_bf16 v[32:35], v[136:139], v[208:211], v[32:35]
  v_mfma_f32_16x16x32_bf16 v[36:39], v[136:139], v[212:215], v[36:39]
  s_waitcnt lgkmcnt(0)
  v_mfma_f32_16x16x32_bf16 v[32:35], v[140:143], v[216:219], v[32:35]
  v_mfma_f32_16x16x32_bf16 v[36:39], v[140:143], v[220:223], v[36:39]
  s_nop 7
  v_mov_b32 v33, v36
  ds_write_b64 v10, v[32:33] offset:10752
  s_waitcnt lgkmcnt(0)
  s_barrier
  ds_read_b64 v[144:145], v16 offset:10752
  ds_read_b64 v[146:147], v16 offset:11264
  ds_read_b64 v[148:149], v16 offset:11776
  ds_read_b64 v[150:151], v16 offset:12288
  s_waitcnt lgkmcnt(0)
  v_pk_add_f32 v[144:145], v[144:145], v[146:147]
  v_pk_add_f32 v[148:149], v[148:149], v[150:151]
  v_pk_add_f32 v[144:145], v[144:145], v[148:149]
  v_cvt_pk_bf16_f32 v144, 0, v144
  v_cvt_pk_bf16_f32 v145, 0, v145
  v_mul_f32 v146, 0xbfb8aa3b, v144
  v_mul_f32 v147, 0xbfb8aa3b, v145
  v_exp_f32 v146, v146
  v_exp_f32 v147, v147
  v_add_f32 v146, 1.0, v146
  v_add_f32 v147, 1.0, v147
  v_rcp_f32 v146, v146
  v_rcp_f32 v147, v147
  v_mul_f32 v144, v144, v146
  v_mul_f32 v145, v145, v147
  v_cvt_pk_bf16_f32 v144, v144, v145
  s_nop 1
  v_mov_b32_dpp v148, v144 quad_perm:[0,0,0,0] row_mask:0xf bank_mask:0xf
  v_mov_b32_dpp v149, v144 quad_perm:[1,1,1,1] row_mask:0xf bank_mask:0xf
  v_mov_b32_dpp v150, v144 quad_perm:[2,2,2,2] row_mask:0xf bank_mask:0xf
  v_mov_b32_dpp v151, v144 quad_perm:[3,3,3,3] row_mask:0xf bank_mask:0xf
  s_nop 1
  v_mfma_f32_16x16x32_bf16 v[32:35], v[148:151], v[224:227], 0
  v_mfma_f32_16x16x32_bf16 v[36:39], v[148:151], v[228:231], 0
  v_mfma_f32_16x16x32_bf16 v[40:43], v[148:151], v[232:235], 0
  v_mfma_f32_16x16x32_bf16 v[44:47], v[148:151], v[236:239], 0
  v_mfma_f32_16x16x32_bf16 v[48:51], v[148:151], v[240:243], 0
  v_mfma_f32_16x16x32_bf16 v[52:55], v[148:151], v[244:247], 0
  v_mfma_f32_16x16x32_bf16 v[56:59], v[148:151], v[248:251], 0
  v_mfma_f32_16x16x32_bf16 v[60:63], v[148:151], v[252:255], 0
  s_nop 0
  v_add_u32 v152, 0x800, v32
  v_add_u32 v153, 0x800, v36
  v_add_u32 v154, 0x800, v40
  v_add_u32 v155, 0x800, v44
  v_and_or_b32 v152, v152, v0, s12
  v_and_or_b32 v153, v153, v0, s13
  v_and_or_b32 v154, v154, v0, s14
  v_and_or_b32 v155, v155, v0, s15
  buffer_store_dwordx4 v[152:155], v18, s[44:47], s94 offen sc1
  v_add_u32 v156, 0x800, v48
  v_add_u32 v157, 0x800, v52
  v_add_u32 v158, 0x800, v56
  v_add_u32 v159, 0x800, v60
  v_and_or_b32 v156, v156, v0, s12
  v_and_or_b32 v157, v157, v0, s13
  v_and_or_b32 v158, v158, v0, s14
  v_and_or_b32 v159, v159, v0, s15
  buffer_store_dwordx4 v[156:159], v18, s[44:47], s95 offen sc1
L_fin:
  s_endpgm
L_WO:
  s_cmp_lg_u32 s35, 1
  s_cselect_b64 vcc, -1, 0
  s_mov_b64 vcc, 0
  v_lshlrev_b32 v8, 10, v3
  v_lshl_add_u32 v8, v2, 4, v8
  s_lshl_b32 s94, s31, 17
  s_lshl_b32 s89, s35, 8
  s_add_u32 s94, s94, s89
  s_bfe_u32 s89, s31, 131072
  s_lshl_b32 s89, s89, 15
  s_add_u32 s94, s94, s89
  s_xor_b32 s89, s94, 0
  buffer_load_dwordx4 v[96:99], v8, s[56:59], s89 offen offset:0 nt
  s_xor_b32 s89, s94, 4096
  buffer_load_dwordx4 v[100:103], v8, s[56:59], s89 offen offset:0 nt
  s_cbranch_vccz L_t_126
  s_waitcnt vmcnt(1)
L_t_126:
  s_xor_b32 s89, s94, 8192
  buffer_load_dwordx4 v[104:107], v8, s[56:59], s89 offen offset:0 nt
  s_cbranch_vccz L_t_127
  s_waitcnt vmcnt(1)
L_t_127:
  s_waitcnt vmcnt(2)
  s_xor_b32 s89, s94, 12288
  buffer_load_dwordx4 v[108:111], v8, s[56:59], s89 offen offset:0 nt
  s_cbranch_vccz L_t_128
  s_waitcnt vmcnt(1)
L_t_128:
  s_waitcnt vmcnt(2)
  s_xor_b32 s89, s94, 16384
  buffer_load_dwordx4 v[112:115], v8, s[56:59], s89 offen offset:0 nt
  s_cbranch_vccz L_t_129
  s_waitcnt vmcnt(1)
L_t_129:
  s_waitcnt vmcnt(2)
  s_xor_b32 s89, s94, 20480
  buffer_load_dwordx4 v[116:119], v8, s[56:59], s89 offen offset:0 nt
  s_cbranch_vccz L_t_130
  s_waitcnt vmcnt(1)
L_t_130:
  s_waitcnt vmcnt(2)
  s_xor_b32 s89, s94, 24576
  buffer_load_dwordx4 v[120:123], v8, s[56:59], s89 offen offset:0 nt
  s_cbranch_vccz L_t_131
  s_waitcnt vmcnt(1)
L_t_131:
  s_waitcnt vmcnt(2)
  s_xor_b32 s89, s94, 28672
  buffer_load_dwordx4 v[124:127], v8, s[56:59], s89 offen offset:0 nt
  s_cbranch_vccz L_t_132
  s_waitcnt vmcnt(1)
L_t_132:
  s_waitcnt vmcnt(2)
  s_xor_b32 s89, s94, 32768
  buffer_load_dwordx4 v[128:131], v8, s[56:59], s89 offen offset:0 nt
  s_cbranch_vccz L_t_133
  s_waitcnt vmcnt(1)
L_t_133:
  s_waitcnt vmcnt(2)
  s_xor_b32 s89, s94, 36864
  buffer_load_dwordx4 v[132:135], v8, s[56:59], s89 offen offset:0 nt
  s_cbranch_vccz L_t_134
  s_waitcnt vmcnt(1)
L_t_134:
  s_waitcnt vmcnt(2)
  s_xor_b32 s89, s94, 40960
  buffer_load_dwordx4 v[136:139], v8, s[56:59], s89 offen offset:0 nt
  s_cbranch_vccz L_t_135
  s_waitcnt vmcnt(1)
L_t_135:
  s_waitcnt vmcnt(2)
  s_xor_b32 s89, s94, 45056
  buffer_load_dwordx4 v[140:143], v8, s[56:59], s89 offen offset:0 nt
  s_cbranch_vccz L_t_136
  s_waitcnt vmcnt(1)
L_t_136:
  s_waitcnt vmcnt(2)
  s_xor_b32 s89, s94, 49152
  buffer_load_dwordx4 v[144:147], v8, s[56:59], s89 offen offset:0 nt
  s_cbranch_vccz L_t_137
  s_waitcnt vmcnt(1)
L_t_137:
  s_waitcnt vmcnt(2)
  s_xor_b32 s89, s94, 53248
  buffer_load_dwordx4 v[148:151], v8, s[56:59], s89 offen offset:0 nt
  s_cbranch_vccz L_t_138
  s_waitcnt vmcnt(1)
L_t_138:
  s_waitcnt vmcnt(2)
  s_xor_b32 s89, s94, 57344
  buffer_load_dwordx4 v[152:155], v8, s[56:59], s89 offen offset:0 nt
  s_cbranch_vccz L_t_139
  s_waitcnt vmcnt(1)
L_t_139:
  s_waitcnt vmcnt(2)
  s_xor_b32 s89, s94, 61440
  buffer_load_dwordx4 v[156:159], v8, s[56:59], s89 offen offset:0 nt
  s_cbranch_vccz L_t_140
  s_waitcnt vmcnt(1)
L_t_140:
  s_waitcnt vmcnt(2)
  s_xor_b32 s89, s94, 65536
  buffer_load_dwordx4 v[160:163], v8, s[56:59], s89 offen offset:0 nt
  s_cbranch_vccz L_t_141
  s_waitcnt vmcnt(1)
L_t_141:
  s_waitcnt vmcnt(2)
  s_xor_b32 s89, s94, 69632
  buffer_load_dwordx4 v[164:167], v8, s[56:59], s89 offen offset:0 nt
  s_cbranch_vccz L_t_142
  s_waitcnt vmcnt(1)
L_t_142:
  s_waitcnt vmcnt(2)
  s_xor_b32 s89, s94, 73728
  buffer_load_dwordx4 v[168:171], v8, s[56:59], s89 offen offset:0 nt
  s_cbranch_vccz L_t_143
  s_waitcnt vmcnt(1)
L_t_143:
  s_waitcnt vmcnt(2)
  s_xor_b32 s89, s94, 77824
  buffer_load_dwordx4 v[172:175], v8, s[56:59], s89 offen offset:0 nt
  s_cbranch_vccz L_t_144
  s_waitcnt vmcnt(1)
L_t_144:
  s_waitcnt vmcnt(2)
  s_xor_b32 s89, s94, 81920
  buffer_load_dwordx4 v[176:179], v8, s[56:59], s89 offen offset:0 nt
  s_cbranch_vccz L_t_145
  s_waitcnt vmcnt(1)
L_t_145:
  s_waitcnt vmcnt(2)
  s_xor_b32 s89, s94, 86016
  buffer_load_dwordx4 v[180:183], v8, s[56:59], s89 offen offset:0 nt
  s_cbranch_vccz L_t_146
  s_waitcnt vmcnt(1)
L_t_146:
  s_waitcnt vmcnt(2)
  s_xor_b32 s89, s94, 90112
  buffer_load_dwordx4 v[184:187], v8, s[56:59], s89 offen offset:0 nt
  s_cbranch_vccz L_t_147
  s_waitcnt vmcnt(1)
L_t_147:
  s_waitcnt vmcnt(2)
  s_xor_b32 s89, s94, 94208
  buffer_load_dwordx4 v[188:191], v8, s[56:59], s89 offen offset:0 nt
  s_cbranch_vccz L_t_148
  s_waitcnt vmcnt(1)
L_t_148:
  s_waitcnt vmcnt(2)
  s_xor_b32 s89, s94, 98304
  buffer_load_dwordx4 v[32:35], v8, s[56:59], s89 offen offset:0 nt
  s_cbranch_vccz L_t_149
  s_waitcnt vmcnt(1)
L_t_149:
  s_waitcnt vmcnt(2)
  s_xor_b32 s89, s94, 102400
  buffer_load_dwordx4 v[36:39], v8, s[56:59], s89 offen offset:0 nt
  s_cbranch_vccz L_t_150
  s_waitcnt vmcnt(1)
L_t_150:
  s_waitcnt vmcnt(2)
  s_xor_b32 s89, s94, 106496
  buffer_load_dwordx4 v[40:43], v8, s[56:59], s89 offen offset:0 nt
  s_cbranch_vccz L_t_151
  s_waitcnt vmcnt(1)
L_t_151:
  s_waitcnt vmcnt(2)
  s_xor_b32 s89, s94, 110592
  buffer_load_dwordx4 v[44:47], v8, s[56:59], s89 offen offset:0 nt
  s_cbranch_vccz L_t_152
  s_waitcnt vmcnt(1)
L_t_152:
  s_waitcnt vmcnt(2)
  s_xor_b32 s89, s94, 114688
  buffer_load_dwordx4 v[48:51], v8, s[56:59], s89 offen offset:0 nt
  s_cbranch_vccz L_t_153
  s_waitcnt vmcnt(1)
L_t_153:
  s_waitcnt vmcnt(2)
  s_xor_b32 s89, s94, 118784
  buffer_load_dwordx4 v[52:55], v8, s[56:59], s89 offen offset:0 nt
  s_cbranch_vccz L_t_154
  s_waitcnt vmcnt(1)
L_t_154:
  s_waitcnt vmcnt(2)
  s_xor_b32 s89, s94, 122880
  buffer_load_dwordx4 v[56:59], v8, s[56:59], s89 offen offset:0 nt
  s_cbranch_vccz L_t_155
  s_waitcnt vmcnt(1)
L_t_155:
  s_waitcnt vmcnt(2)
  s_xor_b32 s89, s94, 126976
  buffer_load_dwordx4 v[60:63], v8, s[56:59], s89 offen offset:0 nt
  s_waitcnt vmcnt(0)
  v_perm_b32 v64, v100, v96, s86
  v_perm_b32 v65, v108, v104, s86
  v_perm_b32 v66, v116, v112, s86
  v_perm_b32 v67, v124, v120, s86
  v_perm_b32 v68, v100, v96, s87
  v_perm_b32 v69, v108, v104, s87
  v_perm_b32 v70, v116, v112, s87
  v_perm_b32 v71, v124, v120, s87
  v_perm_b32 v72, v101, v97, s86
  v_perm_b32 v73, v109, v105, s86
  v_perm_b32 v74, v117, v113, s86
  v_perm_b32 v75, v125, v121, s86
  v_perm_b32 v76, v101, v97, s87
  v_perm_b32 v77, v109, v105, s87
  v_perm_b32 v78, v117, v113, s87
  v_perm_b32 v79, v125, v121, s87
  v_perm_b32 v80, v102, v98, s86
  v_perm_b32 v81, v110, v106, s86
  v_perm_b32 v82, v118, v114, s86
  v_perm_b32 v83, v126, v122, s86
  v_perm_b32 v84, v102, v98, s87
  v_perm_b32 v85, v110, v106, s87
  v_perm_b32 v86, v118, v114, s87
  v_perm_b32 v87, v126, v122, s87
  v_perm_b32 v88, v103, v99, s86
  v_perm_b32 v89, v111, v107, s86
  v_perm_b32 v90, v119, v115, s86
  v_perm_b32 v91, v127, v123, s86
  v_perm_b32 v92, v103, v99, s87
  v_perm_b32 v93, v111, v107, s87
  v_perm_b32 v94, v119, v115, s87
  v_perm_b32 v95, v127, v123, s87
  v_perm_b32 v96, v132, v128, s86
  v_perm_b32 v97, v140, v136, s86
  v_perm_b32 v98, v148, v144, s86
  v_perm_b32 v99, v156, v152, s86
  v_perm_b32 v100, v132, v128, s87
  v_perm_b32 v101, v140, v136, s87
  v_perm_b32 v102, v148, v144, s87
  v_perm_b32 v103, v156, v152, s87
  v_perm_b32 v104, v133, v129, s86
  v_perm_b32 v105, v141, v137, s86
  v_perm_b32 v106, v149, v145, s86
  v_perm_b32 v107, v157, v153, s86
  v_perm_b32 v108, v133, v129, s87
  v_perm_b32 v109, v141, v137, s87
  v_perm_b32 v110, v149, v145, s87
  v_perm_b32 v111, v157, v153, s87
  v_perm_b32 v112, v134, v130, s86
  v_perm_b32 v113, v142, v138, s86
  v_perm_b32 v114, v150, v146, s86
  v_perm_b32 v115, v158, v154, s86
  v_perm_b32 v116, v134, v130, s87
  v_perm_b32 v117, v142, v138, s87
  v_perm_b32 v118, v150, v146, s87
  v_perm_b32 v119, v158, v154, s87
  v_perm_b32 v120, v135, v131, s86
  v_perm_b32 v121, v143, v139, s86
  v_perm_b32 v122, v151, v147, s86
  v_perm_b32 v123, v159, v155, s86
  v_perm_b32 v124, v135, v131, s87
  v_perm_b32 v125, v143, v139, s87
  v_perm_b32 v126, v151, v147, s87
  v_perm_b32 v127, v159, v155, s87
  v_perm_b32 v128, v164, v160, s86
  v_perm_b32 v129, v172, v168, s86
  v_perm_b32 v130, v180, v176, s86
  v_perm_b32 v131, v188, v184, s86
  v_perm_b32 v132, v164, v160, s87
  v_perm_b32 v133, v172, v168, s87
  v_perm_b32 v134, v180, v176, s87
  v_perm_b32 v135, v188, v184, s87
  v_perm_b32 v136, v165, v161, s86
  v_perm_b32 v137, v173, v169, s86
  v_perm_b32 v138, v181, v177, s86
  v_perm_b32 v139, v189, v185, s86
  v_perm_b32 v140, v165, v161, s87
  v_perm_b32 v141, v173, v169, s87
  v_perm_b32 v142, v181, v177, s87
  v_perm_b32 v143, v189, v185, s87
  v_perm_b32 v144, v166, v162, s86
  v_perm_b32 v145, v174, v170, s86
  v_perm_b32 v146, v182, v178, s86
  v_perm_b32 v147, v190, v186, s86
  v_perm_b32 v148, v166, v162, s87
  v_perm_b32 v149, v174, v170, s87
  v_perm_b32 v150, v182, v178, s87
  v_perm_b32 v151, v190, v186, s87
  v_perm_b32 v152, v167, v163, s86
  v_perm_b32 v153, v175, v171, s86
  v_perm_b32 v154, v183, v179, s86
  v_perm_b32 v155, v191, v187, s86
  v_perm_b32 v156, v167, v163, s87
  v_perm_b32 v157, v175, v171, s87
  v_perm_b32 v158, v183, v179, s87
  v_perm_b32 v159, v191, v187, s87
  v_perm_b32 v160, v36, v32, s86
  v_perm_b32 v161, v44, v40, s86
  v_perm_b32 v162, v52, v48, s86
  v_perm_b32 v163, v60, v56, s86
  v_perm_b32 v164, v36, v32, s87
  v_perm_b32 v165, v44, v40, s87
  v_perm_b32 v166, v52, v48, s87
  v_perm_b32 v167, v60, v56, s87
  v_perm_b32 v168, v37, v33, s86
  v_perm_b32 v169, v45, v41, s86
  v_perm_b32 v170, v53, v49, s86
  v_perm_b32 v171, v61, v57, s86
  v_perm_b32 v172, v37, v33, s87
  v_perm_b32 v173, v45, v41, s87
  v_perm_b32 v174, v53, v49, s87
  v_perm_b32 v175, v61, v57, s87
  v_perm_b32 v176, v38, v34, s86
  v_perm_b32 v177, v46, v42, s86
  v_perm_b32 v178, v54, v50, s86
  v_perm_b32 v179, v62, v58, s86
  v_perm_b32 v180, v38, v34, s87
  v_perm_b32 v181, v46, v42, s87
  v_perm_b32 v182, v54, v50, s87
  v_perm_b32 v183, v62, v58, s87
  v_perm_b32 v184, v39, v35, s86
  v_perm_b32 v185, v47, v43, s86
  v_perm_b32 v186, v55, v51, s86
  v_perm_b32 v187, v63, v59, s86
  v_perm_b32 v188, v39, v35, s87
  v_perm_b32 v189, v47, v43, s87
  v_perm_b32 v190, v55, v51, s87
  v_perm_b32 v191, v63, v59, s87
  s_cbranch_vccnz L_noQ2
  s_branch L_afterWO
L_M:
  s_sub_u32 s37, s2, 16
  s_lshl_b32 s89, s37, 7
  s_mul_i32 s94, s35, 786432
  s_add_u32 s94, s94, s89
  v_lshlrev_b32 v8, 10, v6
  v_lshl_add_u32 v8, v3, 5, v8
  v_and_b32 v9, 1, v2
  v_lshl_add_u32 v8, v9, 4, v8
  s_lshl_b32 s88, s35, 8
  v_lshrrev_b32 v9, 3, v1
  v_mul_u32_u24 v9, 49152, v9
  v_and_b32 v10, 7, v1
  v_lshl_add_u32 v9, v10, 4, v9
  buffer_load_dwordx4 v[20:23], v8, s[68:71], s88 offen offset:0
  buffer_load_dwordx4 v[24:27], v8, s[68:71], s88 offen offset:128
  s_add_u32 s89, s94, 0
  buffer_load_dwordx4 v[192:195], v9, s[72:75], s89 offen nt
  s_add_u32 s89, s94, 6144
  buffer_load_dwordx4 v[196:199], v9, s[72:75], s89 offen nt
  s_add_u32 s89, s94, 12288
  buffer_load_dwordx4 v[200:203], v9, s[72:75], s89 offen nt
  s_waitcnt vmcnt(2)
  s_add_u32 s89, s94, 18432
  buffer_load_dwordx4 v[204:207], v9, s[72:75], s89 offen nt
  s_waitcnt vmcnt(2)
  s_add_u32 s89, s94, 24576
  buffer_load_dwordx4 v[208:211], v9, s[72:75], s89 offen nt
  s_waitcnt vmcnt(2)
  s_add_u32 s89, s94, 30720
  buffer_load_dwordx4 v[212:215], v9, s[72:75], s89 offen nt
  s_waitcnt vmcnt(2)
  s_add_u32 s89, s94, 36864
  buffer_load_dwordx4 v[216:219], v9, s[72:75], s89 offen nt
  s_waitcnt vmcnt(2)
  s_add_u32 s89, s94, 43008
  buffer_load_dwordx4 v[220:223], v9, s[72:75], s89 offen nt
  s_waitcnt vmcnt(2)
  s_add_u32 s89, s94, 393216
  buffer_load_dwordx4 v[224:227], v9, s[72:75], s89 offen nt
  s_waitcnt vmcnt(2)
  s_add_u32 s89, s94, 399360
  buffer_load_dwordx4 v[228:231], v9, s[72:75], s89 offen nt
  s_waitcnt vmcnt(2)
  s_add_u32 s89, s94, 405504
  buffer_load_dwordx4 v[232:235], v9, s[72:75], s89 offen nt
  s_waitcnt vmcnt(2)
  s_add_u32 s89, s94, 411648
  buffer_load_dwordx4 v[236:239], v9, s[72:75], s89 offen nt
  s_waitcnt vmcnt(2)
  s_add_u32 s89, s94, 417792
  buffer_load_dwordx4 v[240:243], v9, s[72:75], s89 offen nt
  s_waitcnt vmcnt(2)
  s_add_u32 s89, s94, 423936
  buffer_load_dwordx4 v[244:247], v9, s[72:75], s89 offen nt
  s_waitcnt vmcnt(2)
  s_add_u32 s89, s94, 430080
  buffer_load_dwordx4 v[248:251], v9, s[72:75], s89 offen nt
  s_waitcnt vmcnt(2)
  s_add_u32 s89, s94, 436224
  buffer_load_dwordx4 v[252:255], v9, s[72:75], s89 offen nt
  v_lshlrev_b32 v32, 16, v20
  v_and_b32 v33, 0xffff0000, v20
  v_lshlrev_b32 v34, 16, v21
  v_and_b32 v35, 0xffff0000, v21
  v_lshlrev_b32 v36, 16, v22
  v_and_b32 v37, 0xffff0000, v22
  v_lshlrev_b32 v38, 16, v23
  v_and_b32 v39, 0xffff0000, v23
  v_lshlrev_b32 v40, 16, v24
  v_and_b32 v41, 0xffff0000, v24
  v_lshlrev_b32 v42, 16, v25
  v_and_b32 v43, 0xffff0000, v25
  v_lshlrev_b32 v44, 16, v26
  v_and_b32 v45, 0xffff0000, v26
  v_lshlrev_b32 v46, 16, v27
  v_and_b32 v47, 0xffff0000, v27
  v_mul_f32 v48, 0xbfb8aa3b, v32
  v_mul_f32 v49, 0xbfb8aa3b, v33
  v_mul_f32 v50, 0xbfb8aa3b, v34
  v_mul_f32 v51, 0xbfb8aa3b, v35
  v_mul_f32 v52, 0xbfb8aa3b, v36
  v_mul_f32 v53, 0xbfb8aa3b, v37
  v_mul_f32 v54, 0xbfb8aa3b, v38
  v_mul_f32 v55, 0xbfb8aa3b, v39
  v_mul_f32 v56, 0xbfb8aa3b, v40
  v_mul_f32 v57, 0xbfb8aa3b, v41
  v_mul_f32 v58, 0xbfb8aa3b, v42
  v_mul_f32 v59, 0xbfb8aa3b, v43
  v_mul_f32 v60, 0xbfb8aa3b, v44
  v_mul_f32 v61, 0xbfb8aa3b, v45
  v_mul_f32 v62, 0xbfb8aa3b, v46
  v_mul_f32 v63, 0xbfb8aa3b, v47
  v_exp_f32 v48, v48
  v_exp_f32 v49, v49
  v_exp_f32 v50, v50
  v_exp_f32 v51, v51
  v_exp_f32 v52, v52
  v_exp_f32 v53, v53
  v_exp_f32 v54, v54
  v_exp_f32 v55, v55
  v_exp_f32 v56, v56
  v_exp_f32 v57, v57
  v_exp_f32 v58, v58
  v_exp_f32 v59, v59
  v_exp_f32 v60, v60
  v_exp_f32 v61, v61
  v_exp_f32 v62, v62
  v_exp_f32 v63, v63
  v_add_f32 v48, 1.0, v48
  v_add_f32 v49, 1.0, v49
  v_add_f32 v50, 1.0, v50
  v_add_f32 v51, 1.0, v51
  v_add_f32 v52, 1.0, v52
  v_add_f32 v53, 1.0, v53
  v_add_f32 v54, 1.0, v54
  v_add_f32 v55, 1.0, v55
  v_add_f32 v56, 1.0, v56
  v_add_f32 v57, 1.0, v57
  v_add_f32 v58, 1.0, v58
  v_add_f32 v59, 1.0, v59
  v_add_f32 v60, 1.0, v60
  v_add_f32 v61, 1.0, v61
  v_add_f32 v62, 1.0, v62
  v_add_f32 v63, 1.0, v63
  v_rcp_f32 v48, v48
  v_rcp_f32 v49, v49
  v_rcp_f32 v50, v50
  v_rcp_f32 v51, v51
  v_rcp_f32 v52, v52
  v_rcp_f32 v53, v53
  v_rcp_f32 v54, v54
  v_rcp_f32 v55, v55
  v_rcp_f32 v56, v56
  v_rcp_f32 v57, v57
  v_rcp_f32 v58, v58
  v_rcp_f32 v59, v59
  v_rcp_f32 v60, v60
  v_rcp_f32 v61, v61
  v_rcp_f32 v62, v62
  v_rcp_f32 v63, v63
  v_mul_f32 v32, v32, v48
  v_mul_f32 v33, v33, v49
  v_mul_f32 v34, v34, v50
  v_mul_f32 v35, v35, v51
  v_mul_f32 v36, v36, v52
  v_mul_f32 v37, v37, v53
  v_mul_f32 v38, v38, v54
  v_mul_f32 v39, v39, v55
  v_mul_f32 v40, v40, v56
  v_mul_f32 v41, v41, v57
  v_mul_f32 v42, v42, v58
  v_mul_f32 v43, v43, v59
  v_mul_f32 v44, v44, v60
  v_mul_f32 v45, v45, v61
  v_mul_f32 v46, v46, v62
  v_mul_f32 v47, v47, v63
  v_cvt_pk_bf16_f32 v20, v32, v33
  v_cvt_pk_bf16_f32 v21, v34, v35
  v_cvt_pk_bf16_f32 v22, v36, v37
  v_cvt_pk_bf16_f32 v23, v38, v39
  v_cvt_pk_bf16_f32 v24, v40, v41
  v_cvt_pk_bf16_f32 v25, v42, v43
  v_cvt_pk_bf16_f32 v26, v44, v45
  v_cvt_pk_bf16_f32 v27, v46, v47
  v_lshrrev_b32 v8, 3, v2
  v_lshl_add_u32 v8, v10, 1, v8
  v_lshlrev_b32 v8, 4, v8
  v_lshl_add_u32 v8, v3, 8, v8
  s_lshl_b32 s88, s35, 10
  v_add_u32 v8, s88, v8
  s_waitcnt vmcnt(8)
  v_perm_b32 v12, v196, v192, s86
  v_perm_b32 v13, v204, v200, s86
  v_perm_b32 v14, v212, v208, s86
  v_perm_b32 v15, v220, v216, s86
  v_perm_b32 v16, v196, v192, s87
  v_perm_b32 v17, v204, v200, s87
  v_perm_b32 v18, v212, v208, s87
  v_perm_b32 v19, v220, v216, s87
  v_mfma_f32_16x16x32_bf16 v[32:35], v[20:23], v[12:15], 0
  s_nop 0
  v_mfma_f32_16x16x32_bf16 v[36:39], v[20:23], v[16:19], 0
  v_perm_b32 v12, v197, v193, s86
  v_perm_b32 v13, v205, v201, s86
  v_perm_b32 v14, v213, v209, s86
  v_perm_b32 v15, v221, v217, s86
  v_perm_b32 v16, v197, v193, s87
  v_perm_b32 v17, v205, v201, s87
  v_perm_b32 v18, v213, v209, s87
  v_perm_b32 v19, v221, v217, s87
  v_mfma_f32_16x16x32_bf16 v[40:43], v[20:23], v[12:15], 0
  s_nop 0
  v_mfma_f32_16x16x32_bf16 v[44:47], v[20:23], v[16:19], 0
  v_perm_b32 v12, v198, v194, s86
  v_perm_b32 v13, v206, v202, s86
  v_perm_b32 v14, v214, v210, s86
  v_perm_b32 v15, v222, v218, s86
  v_perm_b32 v16, v198, v194, s87
  v_perm_b32 v17, v206, v202, s87
  v_perm_b32 v18, v214, v210, s87
  v_perm_b32 v19, v222, v218, s87
  v_mfma_f32_16x16x32_bf16 v[48:51], v[20:23], v[12:15], 0
  s_nop 0
  v_mfma_f32_16x16x32_bf16 v[52:55], v[20:23], v[16:19], 0
  v_perm_b32 v12, v199, v195, s86
  v_perm_b32 v13, v207, v203, s86
  v_perm_b32 v14, v215, v211, s86
  v_perm_b32 v15, v223, v219, s86
  v_perm_b32 v16, v199, v195, s87
  v_perm_b32 v17, v207, v203, s87
  v_perm_b32 v18, v215, v211, s87
  v_perm_b32 v19, v223, v219, s87
  v_mfma_f32_16x16x32_bf16 v[56:59], v[20:23], v[12:15], 0
  s_nop 0
  v_mfma_f32_16x16x32_bf16 v[60:63], v[20:23], v[16:19], 0
  s_waitcnt vmcnt(0)
  v_perm_b32 v12, v228, v224, s86
  v_perm_b32 v13, v236, v232, s86
  v_perm_b32 v14, v244, v240, s86
  v_perm_b32 v15, v252, v248, s86
  v_perm_b32 v16, v228, v224, s87
  v_perm_b32 v17, v236, v232, s87
  v_perm_b32 v18, v244, v240, s87
  v_perm_b32 v19, v252, v248, s87
  v_mfma_f32_16x16x32_bf16 v[32:35], v[24:27], v[12:15], v[32:35]
  s_nop 0
  v_mfma_f32_16x16x32_bf16 v[36:39], v[24:27], v[16:19], v[36:39]
  v_perm_b32 v12, v229, v225, s86
  v_perm_b32 v13, v237, v233, s86
  v_perm_b32 v14, v245, v241, s86
  v_perm_b32 v15, v253, v249, s86
  v_perm_b32 v16, v229, v225, s87
  v_perm_b32 v17, v237, v233, s87
  v_perm_b32 v18, v245, v241, s87
  v_perm_b32 v19, v253, v249, s87
  v_mfma_f32_16x16x32_bf16 v[40:43], v[24:27], v[12:15], v[40:43]
  s_nop 0
  v_mfma_f32_16x16x32_bf16 v[44:47], v[24:27], v[16:19], v[44:47]
  v_perm_b32 v12, v230, v226, s86
  v_perm_b32 v13, v238, v234, s86
  v_perm_b32 v14, v246, v242, s86
  v_perm_b32 v15, v254, v250, s86
  v_perm_b32 v16, v230, v226, s87
  v_perm_b32 v17, v238, v234, s87
  v_perm_b32 v18, v246, v242, s87
  v_perm_b32 v19, v254, v250, s87
  v_mfma_f32_16x16x32_bf16 v[48:51], v[24:27], v[12:15], v[48:51]
  s_nop 0
  v_mfma_f32_16x16x32_bf16 v[52:55], v[24:27], v[16:19], v[52:55]
  v_perm_b32 v12, v231, v227, s86
  v_perm_b32 v13, v239, v235, s86
  v_perm_b32 v14, v247, v243, s86
  v_perm_b32 v15, v255, v251, s86
  v_perm_b32 v16, v231, v227, s87
  v_perm_b32 v17, v239, v235, s87
  v_perm_b32 v18, v247, v243, s87
  v_perm_b32 v19, v255, v251, s87
  v_mfma_f32_16x16x32_bf16 v[56:59], v[24:27], v[12:15], v[56:59]
  s_nop 0
  v_mfma_f32_16x16x32_bf16 v[60:63], v[24:27], v[16:19], v[60:63]
  v_add_f32_dpp v16, v33, v32 row_ror:8 row_mask:0xf bank_mask:0x3
  v_add_f32_dpp v17, v37, v36 row_ror:8 row_mask:0xf bank_mask:0x3
  v_add_f32_dpp v18, v41, v40 row_ror:8 row_mask:0xf bank_mask:0x3
  v_add_f32_dpp v19, v45, v44 row_ror:8 row_mask:0xf bank_mask:0x3
  v_add_f32_dpp v16, v48, v49 row_ror:8 row_mask:0xf bank_mask:0xc
  v_add_f32_dpp v17, v52, v53 row_ror:8 row_mask:0xf bank_mask:0xc
  v_add_f32_dpp v18, v56, v57 row_ror:8 row_mask:0xf bank_mask:0xc
  s_nop 0
  v_add_f32_dpp v19, v60, v61 row_ror:8 row_mask:0xf bank_mask:0xc
  ds_write_b128 v8, v[16:19] offset:2048
  s_waitcnt lgkmcnt(0)
  s_mov_b64 exec, 1
  v_mov_b32 v14, 1
  v_mov_b32 v15, 0
  ds_add_u32 v15, v14 offset:0
  s_mov_b64 exec, -1
  s_cmp_lg_u32 s35, 0
  s_cbranch_scc1 L_afterM
  s_mov_b32 s90, 800000
  v_mov_b32 v15, 0
L_lsp_156:
  ds_read_b32 v14, v15 offset:0
  s_waitcnt lgkmcnt(0)
  v_readfirstlane_b32 s91, v14
  s_cmp_ge_u32 s91, 4
  s_cbranch_scc1 L_ldone_157
  s_sleep 1
  s_sub_u32 s90, s90, 1
  s_cmp_lg_u32 s90, 0
  s_cbranch_scc1 L_lsp_156
L_ldone_157:
  ds_read_b128 v[16:19], v7 offset:2048
  ds_read_b128 v[20:23], v7 offset:3072
  ds_read_b128 v[24:27], v7 offset:4096
  ds_read_b128 v[32:35], v7 offset:5120
  s_waitcnt lgkmcnt(0)
  v_add_f32 v16, v16, v20
  v_add_f32 v24, v24, v32
  v_add_f32 v16, v16, v24
  v_add_f32 v17, v17, v21
  v_add_f32 v25, v25, v33
  v_add_f32 v17, v17, v25
  v_add_f32 v18, v18, v22
  v_add_f32 v26, v26, v34
  v_add_f32 v18, v18, v26
  v_add_f32 v19, v19, v23
  v_add_f32 v27, v27, v35
  v_add_f32 v19, v19, v27
  v_mov_b32 v22, s84
  v_mov_b32 v23, s85
  v_cvt_pk_bf16_f32 v20, v16, v17
  v_cvt_pk_bf16_f32 v21, v18, v19
  s_lshl_b32 s88, s37, 10
  s_add_u32 s88, s88, 4096
  buffer_store_dwordx4 v[20:23], v7, s[44:47], s88 offen sc1
  s_nop 1
  s_branch L_afterM
L_end:
  s_endpgm
L_codeend:
.section .rodata,"a"
.p2align 6
.amdhsa_kernel adaLN_cond__mha_block_cached__dense_activation_silu__decode_kernel
.amdhsa_next_free_vgpr 256
.amdhsa_next_free_sgpr 102
.amdhsa_accum_offset 256
.amdhsa_group_segment_fixed_size 0
.amdhsa_kernarg_size 104
.amdhsa_user_sgpr_count 2
.amdhsa_user_sgpr_kernarg_segment_ptr 1
.amdhsa_system_sgpr_workgroup_id_x 1
.end_amdhsa_kernel
```
